```python
import torch

def _softmax(x, axis=-1):
    return torch.softmax(x, dim=axis)
def _gelu(x):
    return torch.nn.functional.gelu(x, approximate="tanh")
def _silu(x):
    return torch.nn.functional.silu(x)
def _sigmoid(x):
    return torch.sigmoid(x)
def _layernorm(x, axis=-1, eps=1e-5):
    m = x.mean(dim=axis, keepdim=True)
    v = x.var(dim=axis, keepdim=True, unbiased=False)
    return (x - m) / torch.sqrt(v + eps)
def _scatter_add(tgt, idx, src, axis=0):
    return tgt.clone().index_add_(axis, idx, src)
def _segment_sum(src, seg, n):
    out = torch.zeros((n,) + src.shape[1:], dtype=src.dtype)
    return out.index_add_(0, seg, src)
def _pad(x, pw):
    flat = tuple(v for pair in reversed(pw) for v in pair)
    return torch.nn.functional.pad(x, flat)

kernel_name = 'parallel_sum__gqa_block_cached__glu_gated_swiglu__decode'

def setup_inputs():

    _w = (lambda a: (lambda t: t.to(torch.bfloat16) if t.is_floating_point() else t)(torch.as_tensor(a)))
    def _A_setup():
        B, Sq, D = 1, 1, 512
        Hq, Hkv, Sk, Dh = 32, 8, 65536, 128
        assert Hq % Hkv == 0, (Hq, Hkv)
        return {
            "x": _w((lambda *s: torch.randn(*s, dtype=torch.bfloat16) * 0.05)(B, Sq, D)),
            "k_cache": _w((lambda *s: torch.randn(*s, dtype=torch.bfloat16) * 3.2)(B, Hkv, Sk, Dh)),
            "v_cache": _w((lambda *s: torch.randn(*s, dtype=torch.bfloat16) * 1.6)(B, Hkv, Sk, Dh)),
            "wq": _w((lambda *s: torch.randn(*s, dtype=torch.bfloat16) * 3.2)(D, Hq * Dh) * (D ** -0.5)),
            "wo": _w((lambda *s: torch.randn(*s, dtype=torch.bfloat16) * 1.6)(Hq * Dh, D) * ((Hq * Dh) ** -0.5)),
        }
    _A_in = _A_setup()

    def _B_setup():
        B, S, D, F = 1, 1, 512, 1792
        return {
            "x": _w((lambda *s: torch.randn(*s, dtype=torch.bfloat16) * 0.05)(B, S, D)),
            "w1": _w((lambda *s: torch.randn(*s, dtype=torch.bfloat16) * 1.6)(D, F) * (2.0 / D) ** 0.5),
            "w3": _w((lambda *s: torch.randn(*s, dtype=torch.bfloat16) * 1.6)(D, F) * (2.0 / D) ** 0.5),
            "w2": _w((lambda *s: torch.randn(*s, dtype=torch.bfloat16) * 1.6)(F, D) * (2.0 / F) ** 0.5),
        }
    _B_in = _B_setup()

    return {
        "A_x": _A_in["x"],
        "A_k_cache": _A_in["k_cache"],
        "A_v_cache": _A_in["v_cache"],
        "A_wq": _A_in["wq"],
        "A_wo": _A_in["wo"],
        "B_x": _B_in["x"],
        "B_w1": _B_in["w1"],
        "B_w3": _B_in["w3"],
        "B_w2": _B_in["w2"],
    }

def reference(A_x, A_k_cache, A_v_cache, A_wq, A_wo, B_x, B_w1, B_w3, B_w2):
    def _A_ref(x, k_cache, v_cache, wq, wo):
        B, Sq, D = x.shape
        Hq, Dh = 32, 128
        Hkv = k_cache.shape[1]
        rep = Hq // Hkv
        q = (lambda x, *d: x.permute(*d))((x @ wq).reshape(B, Sq, Hq, Dh), 0, 2, 1, 3)
        k = (lambda x, n, axis: torch.repeat_interleave(x, n, dim=axis))(k_cache, rep, axis=1)
        v = (lambda x, n, axis: torch.repeat_interleave(x, n, dim=axis))(v_cache, rep, axis=1)
        scores = torch.einsum("bhqd,bhkd->bhqk", q, k) * (Dh ** -0.5)
        p = _softmax(scores, axis=-1)
        o = torch.einsum("bhqk,bhkd->bhqd", p, v)
        return (lambda x, *d: x.permute(*d))(o, 0, 2, 1, 3).reshape(B, Sq, Hq * Dh) @ wo

    def _B_ref(x, w1, w3, w2):
        gate = torch.einsum("bsd,df->bsf", x, w1)
        up = torch.einsum("bsd,df->bsf", x, w3)
        h = _silu(gate) * up
        out = torch.einsum("bsf,fd->bsd", h, w2)
        return out

    x = A_x
    xn = _layernorm(x, axis=-1)
    return x + _A_ref(xn, A_k_cache, A_v_cache, A_wq, A_wo) + _B_ref(xn, B_w1, B_w3, B_w2)
```

```asm
; @launch grid=(256,1,1) block=(576,1,1) lds=155648
.amdgcn_target "amdgcn-amd-amdhsa--gfx950"
.text
.globl parallel_sum__gqa_block_cached__glu_gated_swiglu__decode_kernel
.p2align 8
.type parallel_sum__gqa_block_cached__glu_gated_swiglu__decode_kernel,@function
parallel_sum__gqa_block_cached__glu_gated_swiglu__decode_kernel:
    s_cmp_ge_u32 s2, 256
    s_cbranch_scc1 L_end
    s_load_dwordx16 s[16:31], s[0:1], 0
    s_load_dwordx8 s[32:39], s[0:1], 64
    v_lshrrev_b32 v1, 6, v0
    v_and_b32 v0, 63, v0
    s_nop 0
    v_readfirstlane_b32 s3, v1
    s_lshr_b32 s4, s2, 5
    s_and_b32 s5, s2, 31
    s_lshr_b32 s6, s2, 3
    s_and_b32 s7, s2, 7
    s_sub_u32 s8, s2, 224
    s_cmp_ge_u32 s2, 224
    s_cselect_b32 s8, s8, s2
    s_cmp_ge_u32 s8, 112
    s_cselect_b32 s9, 1, 0
    s_mul_i32 s10, s9, 112
    s_sub_u32 s10, s8, s10
    s_mov_b32 s11, 0
    s_cmp_ge_u32 s10, 28
    s_addc_u32 s11, s11, 0
    s_cmp_ge_u32 s10, 56
    s_addc_u32 s11, s11, 0
    s_cmp_ge_u32 s10, 84
    s_addc_u32 s11, s11, 0
    s_mul_i32 s12, s11, 28
    s_sub_u32 s12, s10, s12
    s_waitcnt lgkmcnt(0)
    s_mov_b32 s40, s16
    s_mov_b32 s41, s17
    s_mov_b32 s42, 0x400
    s_mov_b32 s43, 0x00020000
    s_mov_b32 s44, s18
    s_mov_b32 s45, s19
    s_mov_b32 s46, 0x8000000
    s_mov_b32 s47, 0x00020000
    s_mov_b32 s48, s20
    s_mov_b32 s49, s21
    s_mov_b32 s50, 0x8000000
    s_mov_b32 s51, 0x00020000
    s_mov_b32 s52, s22
    s_mov_b32 s53, s23
    s_mov_b32 s54, 0x400000
    s_mov_b32 s55, 0x00020000
    s_mov_b32 s56, s24
    s_mov_b32 s57, s25
    s_mov_b32 s58, 0x400000
    s_mov_b32 s59, 0x00020000
    s_cmp_eq_u32 s9, 0
    s_cselect_b32 s60, s28, s30
    s_cselect_b32 s61, s29, s31
    s_mov_b32 s62, 0x1c0000
    s_mov_b32 s63, 0x00020000
    s_mov_b32 s64, s32
    s_mov_b32 s65, s33
    s_mov_b32 s66, 0x1c0000
    s_mov_b32 s67, 0x00020000
    s_mov_b32 s68, s34
    s_mov_b32 s69, s35
    s_mov_b32 s70, 0x400
    s_mov_b32 s71, 0x00020000
    s_mov_b32 s72, s36
    s_mov_b32 s73, s37
    s_mov_b32 s74, 0x100
    s_mov_b32 s75, 0x00020000
    s_mov_b32 s76, s38
    s_mov_b32 s77, s39
    s_mov_b32 s78, 0x20000000
    s_mov_b32 s79, 0x00020000
    s_cmp_eq_u32 s3, 8
    s_cbranch_scc1 L_service
    v_lshlrev_b32 v30, 4, v0
    buffer_load_dwordx4 v[32:35], v30, s[40:43], 0 offen
    v_lshrrev_b32 v24, 3, v0
    v_and_b32 v25, 7, v0
    v_lshlrev_b32 v26, 13, v24
    v_lshl_add_u32 v26, v25, 4, v26
    s_lshr_b32 s16, s5, 3
    s_and_b32 s17, s5, 7
    s_lshl_b32 s18, s16, 7
    s_lshl_b32 s19, s3, 4
    s_add_u32 s18, s18, s19
    s_lshl_b32 s19, s18, 13
    s_lshl_b32 s20, s4, 10
    s_add_u32 s19, s19, s20
    s_lshl_b32 s20, s17, 7
    s_add_u32 s19, s19, s20
    s_add_u32 s20, s19, 65536
    buffer_load_dwordx4 v[36:39], v26, s[52:55], s19 offen
    buffer_load_dwordx4 v[40:43], v26, s[52:55], s20 offen
    s_movk_i32 s21, 3584
    v_mul_lo_u32 v27, v24, s21
    v_lshl_add_u32 v27, v25, 4, v27
    s_lshl_b32 s22, s11, 7
    s_lshl_b32 s23, s3, 4
    s_add_u32 s22, s22, s23
    s_mul_i32 s23, s22, 3584
    s_lshl_b32 s24, s12, 7
    s_add_u32 s23, s23, s24
    s_add_u32 s24, s23, 28672
    buffer_load_dwordx4 v[44:47], v27, s[60:63], s23 offen
    buffer_load_dwordx4 v[48:51], v27, s[60:63], s24 offen
    s_lshl_b32 s14, s2, 19
    s_lshl_b32 s15, s3, 12
    s_add_u32 s14, s14, s15
    s_lshl_b32 s15, s3, 14
    s_add_u32 s15, s15, 24576
    v_lshrrev_b32 v20, 4, v0
    v_and_b32 v21, 15, v0
    v_lshlrev_b32 v22, 8, v20
    v_xor_b32 v23, v21, v20
    v_xor_b32 v28, 0, v23
    v_lshl_add_u32 v2, v28, 4, v22
    v_xor_b32 v28, 4, v23
    v_lshl_add_u32 v3, v28, 4, v22
    v_xor_b32 v28, 8, v23
    v_lshl_add_u32 v4, v28, 4, v22
    v_xor_b32 v28, 12, v23
    v_lshl_add_u32 v5, v28, 4, v22
    v_lshlrev_b32 v28, 1, v20
    v_xor_b32 v28, v21, v28
    v_lshl_add_u32 v6, v28, 4, v22
    v_xor_b32 v28, 8, v28
    v_lshl_add_u32 v7, v28, 4, v22
    s_add_u32 s20, s14, 0
    s_add_u32 m0, s15, 0
    s_nop 0
    buffer_load_dwordx4 v2, s[44:47], s20 offen offset:0 nt lds
    buffer_load_dwordx4 v3, s[44:47], s20 offen offset:1024 nt lds
    buffer_load_dwordx4 v4, s[44:47], s20 offen offset:2048 nt lds
    buffer_load_dwordx4 v5, s[44:47], s20 offen offset:3072 nt lds
    s_add_u32 s20, s14, 32768
    s_add_u32 m0, s15, 4096
    s_nop 0
    buffer_load_dwordx4 v2, s[44:47], s20 offen offset:0 nt lds
    buffer_load_dwordx4 v3, s[44:47], s20 offen offset:1024 nt lds
    buffer_load_dwordx4 v4, s[44:47], s20 offen offset:2048 nt lds
    buffer_load_dwordx4 v5, s[44:47], s20 offen offset:3072 nt lds
    v_lshlrev_b32 v29, 8, v21
    v_add_u32 v29, s15, v29
    v_xor_b32 v28, 0, v23
    v_lshl_add_u32 v8, v28, 4, v29
    v_xor_b32 v28, 4, v23
    v_lshl_add_u32 v9, v28, 4, v29
    v_xor_b32 v28, 8, v23
    v_lshl_add_u32 v10, v28, 4, v29
    v_xor_b32 v28, 12, v23
    v_lshl_add_u32 v11, v28, 4, v29
    v_lshrrev_b32 v28, 2, v21
    v_lshl_add_u32 v28, v20, 2, v28
    v_lshlrev_b32 v29, 8, v28
    v_add_u32 v29, s15, v29
    v_and_b32 v28, 7, v28
    v_lshlrev_b32 v28, 1, v28
    v_and_b32 v31, 3, v21
    v_lshrrev_b32 v52, 1, v31
    v_or_b32 v28, v28, v52
    v_and_b32 v31, 1, v31
    v_lshl_add_u32 v29, v31, 3, v29
    v_xor_b32 v52, 0, v28
    v_lshl_add_u32 v12, v52, 4, v29
    v_xor_b32 v52, 2, v28
    v_lshl_add_u32 v13, v52, 4, v29
    v_xor_b32 v52, 4, v28
    v_lshl_add_u32 v14, v52, 4, v29
    v_xor_b32 v52, 6, v28
    v_lshl_add_u32 v15, v52, 4, v29
    v_xor_b32 v52, 8, v28
    v_lshl_add_u32 v16, v52, 4, v29
    v_xor_b32 v52, 10, v28
    v_lshl_add_u32 v17, v52, 4, v29
    v_xor_b32 v52, 12, v28
    v_lshl_add_u32 v18, v52, 4, v29
    v_xor_b32 v52, 14, v28
    v_lshl_add_u32 v19, v52, 4, v29
    s_waitcnt vmcnt(12)
    v_lshlrev_b32 v56, 16, v32
    v_and_b32 v57, 0xffff0000, v32
    v_lshlrev_b32 v58, 16, v33
    v_and_b32 v59, 0xffff0000, v33
    v_lshlrev_b32 v60, 16, v34
    v_and_b32 v61, 0xffff0000, v34
    v_lshlrev_b32 v62, 16, v35
    v_and_b32 v63, 0xffff0000, v35
    v_add_f32 v64, v56, v57
    v_add_f32 v64, v64, v58
    v_add_f32 v64, v64, v59
    v_add_f32 v64, v64, v60
    v_add_f32 v64, v64, v61
    v_add_f32 v64, v64, v62
    v_add_f32 v64, v64, v63
    s_nop 1
    v_add_f32_dpp v64, v64, v64 quad_perm:[1,0,3,2] row_mask:0xf bank_mask:0xf
    s_nop 1
    v_add_f32_dpp v64, v64, v64 quad_perm:[2,3,0,1] row_mask:0xf bank_mask:0xf
    s_nop 1
    v_add_f32_dpp v64, v64, v64 row_ror:4 row_mask:0xf bank_mask:0xf
    s_nop 1
    v_add_f32_dpp v64, v64, v64 row_ror:8 row_mask:0xf bank_mask:0xf
    v_mov_b32 v65, v64
    s_nop 1
    v_permlane16_swap_b32 v64, v65
    s_nop 1
    v_add_f32 v64, v64, v65
    v_mov_b32 v65, v64
    s_nop 1
    v_permlane32_swap_b32 v64, v65
    s_nop 1
    v_add_f32 v64, v64, v65
    v_mul_f32 v64, 0x3b000000, v64
    v_sub_f32 v66, v56, v64
    v_sub_f32 v67, v57, v64
    v_sub_f32 v68, v58, v64
    v_sub_f32 v69, v59, v64
    v_sub_f32 v70, v60, v64
    v_sub_f32 v71, v61, v64
    v_sub_f32 v72, v62, v64
    v_sub_f32 v73, v63, v64
    v_mul_f32 v74, v66, v66
    v_fmac_f32 v74, v67, v67
    v_fmac_f32 v74, v68, v68
    v_fmac_f32 v74, v69, v69
    v_fmac_f32 v74, v70, v70
    v_fmac_f32 v74, v71, v71
    v_fmac_f32 v74, v72, v72
    v_fmac_f32 v74, v73, v73
    s_nop 1
    v_add_f32_dpp v74, v74, v74 quad_perm:[1,0,3,2] row_mask:0xf bank_mask:0xf
    s_nop 1
    v_add_f32_dpp v74, v74, v74 quad_perm:[2,3,0,1] row_mask:0xf bank_mask:0xf
    s_nop 1
    v_add_f32_dpp v74, v74, v74 row_ror:4 row_mask:0xf bank_mask:0xf
    s_nop 1
    v_add_f32_dpp v74, v74, v74 row_ror:8 row_mask:0xf bank_mask:0xf
    v_mov_b32 v65, v74
    s_nop 1
    v_permlane16_swap_b32 v74, v65
    s_nop 1
    v_add_f32 v74, v74, v65
    v_mov_b32 v65, v74
    s_nop 1
    v_permlane32_swap_b32 v74, v65
    s_nop 1
    v_add_f32 v74, v74, v65
    v_mul_f32 v74, 0x3b000000, v74
    v_cvt_pk_bf16_f32 v65, v64, v74
    v_lshlrev_b32 v64, 16, v65
    v_and_b32 v74, 0xffff0000, v65
    v_add_f32 v74, 0x3727c5ac, v74
    v_cvt_pk_bf16_f32 v65, v74, v74
    v_lshlrev_b32 v74, 16, v65
    v_sqrt_f32 v74, v74
    s_nop 0
    v_cvt_pk_bf16_f32 v65, v74, v74
    v_lshlrev_b32 v74, 16, v65
    v_rcp_f32 v75, v74
    v_sub_f32 v56, v56, v64
    v_sub_f32 v57, v57, v64
    v_sub_f32 v58, v58, v64
    v_sub_f32 v59, v59, v64
    v_sub_f32 v60, v60, v64
    v_sub_f32 v61, v61, v64
    v_sub_f32 v62, v62, v64
    v_sub_f32 v63, v63, v64
    v_cvt_pk_bf16_f32 v65, v56, v57
    v_lshlrev_b32 v56, 16, v65
    v_and_b32 v57, 0xffff0000, v65
    v_cvt_pk_bf16_f32 v65, v58, v59
    v_lshlrev_b32 v58, 16, v65
    v_and_b32 v59, 0xffff0000, v65
    v_cvt_pk_bf16_f32 v65, v60, v61
    v_lshlrev_b32 v60, 16, v65
    v_and_b32 v61, 0xffff0000, v65
    v_cvt_pk_bf16_f32 v65, v62, v63
    v_lshlrev_b32 v62, 16, v65
    v_and_b32 v63, 0xffff0000, v65
    v_mul_f32 v66, v56, v75
    v_mul_f32 v67, v57, v75
    v_mul_f32 v68, v58, v75
    v_mul_f32 v69, v59, v75
    v_mul_f32 v70, v60, v75
    v_mul_f32 v71, v61, v75
    v_mul_f32 v72, v62, v75
    v_mul_f32 v73, v63, v75
    v_fma_f32 v76, -v66, v74, v56
    v_fma_f32 v77, -v67, v74, v57
    v_fma_f32 v78, -v68, v74, v58
    v_fma_f32 v79, -v69, v74, v59
    v_fma_f32 v80, -v70, v74, v60
    v_fma_f32 v81, -v71, v74, v61
    v_fma_f32 v82, -v72, v74, v62
    v_fma_f32 v83, -v73, v74, v63
    v_fma_f32 v56, v76, v75, v66
    v_fma_f32 v57, v77, v75, v67
    v_fma_f32 v58, v78, v75, v68
    v_fma_f32 v59, v79, v75, v69
    v_fma_f32 v60, v80, v75, v70
    v_fma_f32 v61, v81, v75, v71
    v_fma_f32 v62, v82, v75, v72
    v_fma_f32 v63, v83, v75, v73
    v_cvt_pk_bf16_f32 v65, v56, v57
    v_lshlrev_b32 v56, 16, v65
    v_and_b32 v57, 0xffff0000, v65
    v_cvt_pk_bf16_f32 v65, v58, v59
    v_lshlrev_b32 v58, 16, v65
    v_and_b32 v59, 0xffff0000, v65
    v_cvt_pk_bf16_f32 v65, v60, v61
    v_lshlrev_b32 v60, 16, v65
    v_and_b32 v61, 0xffff0000, v65
    v_cvt_pk_bf16_f32 v65, v62, v63
    v_lshlrev_b32 v62, 16, v65
    v_and_b32 v63, 0xffff0000, v65
    v_lshlrev_b32 v65, 5, v0
    ds_write_b128 v65, v[56:59] offset:0
    ds_write_b128 v65, v[60:63] offset:16
    v_add_u32 v65, s18, v24
    v_lshlrev_b32 v65, 2, v65
    v_add_u32 v66, s22, v24
    v_lshlrev_b32 v66, 2, v66
    s_waitcnt lgkmcnt(0)
    ds_read_b32 v68, v65 offset:0
    ds_read_b32 v69, v65 offset:32
    ds_read_b32 v70, v66 offset:0
    ds_read_b32 v71, v66 offset:32
    v_mov_b32 v80, 0
    v_mov_b32 v81, 0
    v_mov_b32 v82, 0
    v_mov_b32 v83, 0
    v_mov_b32 v84, 0
    v_mov_b32 v85, 0
    v_mov_b32 v86, 0
    v_mov_b32 v87, 0
    v_mov_b32 v88, 0
    v_mov_b32 v89, 0
    v_mov_b32 v90, 0
    v_mov_b32 v91, 0
    v_mov_b32 v92, 0
    v_mov_b32 v93, 0
    v_mov_b32 v94, 0
    v_mov_b32 v95, 0
    s_waitcnt vmcnt(8) lgkmcnt(0)
    v_lshlrev_b32 v72, 16, v36
    v_and_b32 v73, 0xffff0000, v36
    v_fmac_f32 v80, v68, v72
    v_fmac_f32 v81, v68, v73
    v_lshlrev_b32 v72, 16, v37
    v_and_b32 v73, 0xffff0000, v37
    v_fmac_f32 v82, v68, v72
    v_fmac_f32 v83, v68, v73
    v_lshlrev_b32 v72, 16, v38
    v_and_b32 v73, 0xffff0000, v38
    v_fmac_f32 v84, v68, v72
    v_fmac_f32 v85, v68, v73
    v_lshlrev_b32 v72, 16, v39
    v_and_b32 v73, 0xffff0000, v39
    v_fmac_f32 v86, v68, v72
    v_fmac_f32 v87, v68, v73
    v_lshlrev_b32 v72, 16, v40
    v_and_b32 v73, 0xffff0000, v40
    v_fmac_f32 v80, v69, v72
    v_fmac_f32 v81, v69, v73
    v_lshlrev_b32 v72, 16, v41
    v_and_b32 v73, 0xffff0000, v41
    v_fmac_f32 v82, v69, v72
    v_fmac_f32 v83, v69, v73
    v_lshlrev_b32 v72, 16, v42
    v_and_b32 v73, 0xffff0000, v42
    v_fmac_f32 v84, v69, v72
    v_fmac_f32 v85, v69, v73
    v_lshlrev_b32 v72, 16, v43
    v_and_b32 v73, 0xffff0000, v43
    v_fmac_f32 v86, v69, v72
    v_fmac_f32 v87, v69, v73
    v_lshlrev_b32 v72, 16, v44
    v_and_b32 v73, 0xffff0000, v44
    v_fmac_f32 v88, v70, v72
    v_fmac_f32 v89, v70, v73
    v_lshlrev_b32 v72, 16, v45
    v_and_b32 v73, 0xffff0000, v45
    v_fmac_f32 v90, v70, v72
    v_fmac_f32 v91, v70, v73
    v_lshlrev_b32 v72, 16, v46
    v_and_b32 v73, 0xffff0000, v46
    v_fmac_f32 v92, v70, v72
    v_fmac_f32 v93, v70, v73
    v_lshlrev_b32 v72, 16, v47
    v_and_b32 v73, 0xffff0000, v47
    v_fmac_f32 v94, v70, v72
    v_fmac_f32 v95, v70, v73
    v_lshlrev_b32 v72, 16, v48
    v_and_b32 v73, 0xffff0000, v48
    v_fmac_f32 v88, v71, v72
    v_fmac_f32 v89, v71, v73
    v_lshlrev_b32 v72, 16, v49
    v_and_b32 v73, 0xffff0000, v49
    v_fmac_f32 v90, v71, v72
    v_fmac_f32 v91, v71, v73
    v_lshlrev_b32 v72, 16, v50
    v_and_b32 v73, 0xffff0000, v50
    v_fmac_f32 v92, v71, v72
    v_fmac_f32 v93, v71, v73
    v_lshlrev_b32 v72, 16, v51
    v_and_b32 v73, 0xffff0000, v51
    v_fmac_f32 v94, v71, v72
    v_fmac_f32 v95, v71, v73
    s_nop 1
    v_add_f32_dpp v80, v80, v80 row_ror:8 row_mask:0xf bank_mask:0xf
    v_add_f32_dpp v81, v81, v81 row_ror:8 row_mask:0xf bank_mask:0xf
    v_add_f32_dpp v82, v82, v82 row_ror:8 row_mask:0xf bank_mask:0xf
    v_add_f32_dpp v83, v83, v83 row_ror:8 row_mask:0xf bank_mask:0xf
    v_add_f32_dpp v84, v84, v84 row_ror:8 row_mask:0xf bank_mask:0xf
    v_add_f32_dpp v85, v85, v85 row_ror:8 row_mask:0xf bank_mask:0xf
    v_add_f32_dpp v86, v86, v86 row_ror:8 row_mask:0xf bank_mask:0xf
    v_add_f32_dpp v87, v87, v87 row_ror:8 row_mask:0xf bank_mask:0xf
    v_add_f32_dpp v88, v88, v88 row_ror:8 row_mask:0xf bank_mask:0xf
    v_add_f32_dpp v89, v89, v89 row_ror:8 row_mask:0xf bank_mask:0xf
    v_add_f32_dpp v90, v90, v90 row_ror:8 row_mask:0xf bank_mask:0xf
    v_add_f32_dpp v91, v91, v91 row_ror:8 row_mask:0xf bank_mask:0xf
    v_add_f32_dpp v92, v92, v92 row_ror:8 row_mask:0xf bank_mask:0xf
    v_add_f32_dpp v93, v93, v93 row_ror:8 row_mask:0xf bank_mask:0xf
    v_add_f32_dpp v94, v94, v94 row_ror:8 row_mask:0xf bank_mask:0xf
    v_add_f32_dpp v95, v95, v95 row_ror:8 row_mask:0xf bank_mask:0xf
    s_lshl_b32 s16, s3, 10
    v_lshl_add_u32 v65, v25, 5, v22
    v_add_u32 v65, s16, v65
    ds_write_b128 v65, v[80:83] offset:2048
    ds_write_b128 v65, v[84:87] offset:2064
    ds_write_b128 v65, v[88:91] offset:10240
    ds_write_b128 v65, v[92:95] offset:10256
    s_waitcnt lgkmcnt(0)
    s_barrier
    s_waitcnt vmcnt(2)
    s_add_u32 s20, s14, 65536
    s_add_u32 m0, s15, 8192
    s_nop 0
    buffer_load_dwordx4 v2, s[44:47], s20 offen offset:0 nt lds
    s_waitcnt vmcnt(2)
    buffer_load_dwordx4 v3, s[44:47], s20 offen offset:1024 nt lds
    s_waitcnt vmcnt(2)
    buffer_load_dwordx4 v4, s[44:47], s20 offen offset:2048 nt lds
    s_waitcnt vmcnt(2)
    buffer_load_dwordx4 v5, s[44:47], s20 offen offset:3072 nt lds
    s_waitcnt vmcnt(2)
    s_add_u32 s20, s14, 98304
    s_add_u32 m0, s15, 12288
    s_nop 0
    buffer_load_dwordx4 v2, s[44:47], s20 offen offset:0 nt lds
    s_waitcnt vmcnt(2)
    buffer_load_dwordx4 v3, s[44:47], s20 offen offset:1024 nt lds
    s_waitcnt vmcnt(2)
    buffer_load_dwordx4 v4, s[44:47], s20 offen offset:2048 nt lds
    s_waitcnt vmcnt(2)
    buffer_load_dwordx4 v5, s[44:47], s20 offen offset:3072 nt lds
    s_waitcnt vmcnt(2)
    ds_read_b128 v[32:35], v8 offset:0
    ds_read_b128 v[36:39], v9 offset:0
    ds_read_b128 v[40:43], v10 offset:0
    ds_read_b128 v[44:47], v11 offset:0
    s_waitcnt lgkmcnt(0)
    s_add_u32 s20, s14, 131072
    s_add_u32 m0, s15, 0
    s_nop 0
    buffer_load_dwordx4 v2, s[44:47], s20 offen offset:0 nt lds
    s_waitcnt vmcnt(2)
    buffer_load_dwordx4 v3, s[44:47], s20 offen offset:1024 nt lds
    s_waitcnt vmcnt(2)
    buffer_load_dwordx4 v4, s[44:47], s20 offen offset:2048 nt lds
    s_waitcnt vmcnt(2)
    buffer_load_dwordx4 v5, s[44:47], s20 offen offset:3072 nt lds
    s_waitcnt vmcnt(2)
    ds_read_b128 v[48:51], v8 offset:4096
    ds_read_b128 v[52:55], v9 offset:4096
    ds_read_b128 v[56:59], v10 offset:4096
    ds_read_b128 v[60:63], v11 offset:4096
    s_waitcnt lgkmcnt(0)
    s_add_u32 s20, s14, 163840
    s_add_u32 m0, s15, 4096
    s_nop 0
    buffer_load_dwordx4 v2, s[44:47], s20 offen offset:0 nt lds
    s_waitcnt vmcnt(2)
    buffer_load_dwordx4 v3, s[44:47], s20 offen offset:1024 nt lds
    s_waitcnt vmcnt(2)
    buffer_load_dwordx4 v4, s[44:47], s20 offen offset:2048 nt lds
    s_waitcnt vmcnt(2)
    buffer_load_dwordx4 v5, s[44:47], s20 offen offset:3072 nt lds
    s_waitcnt vmcnt(2)
    ds_read_b128 v[64:67], v8 offset:8192
    ds_read_b128 v[68:71], v9 offset:8192
    ds_read_b128 v[72:75], v10 offset:8192
    ds_read_b128 v[76:79], v11 offset:8192
    s_waitcnt lgkmcnt(0)
    s_add_u32 s20, s14, 196608
    s_add_u32 m0, s15, 8192
    s_nop 0
    buffer_load_dwordx4 v2, s[44:47], s20 offen offset:0 nt lds
    s_waitcnt vmcnt(2)
    buffer_load_dwordx4 v3, s[44:47], s20 offen offset:1024 nt lds
    s_waitcnt vmcnt(2)
    buffer_load_dwordx4 v4, s[44:47], s20 offen offset:2048 nt lds
    s_waitcnt vmcnt(2)
    buffer_load_dwordx4 v5, s[44:47], s20 offen offset:3072 nt lds
    s_waitcnt vmcnt(2)
    ds_read_b128 v[80:83], v8 offset:12288
    ds_read_b128 v[84:87], v9 offset:12288
    ds_read_b128 v[88:91], v10 offset:12288
    ds_read_b128 v[92:95], v11 offset:12288
    s_waitcnt lgkmcnt(0)
    s_add_u32 s20, s14, 229376
    s_add_u32 m0, s15, 12288
    s_nop 0
    buffer_load_dwordx4 v2, s[44:47], s20 offen offset:0 nt lds
    s_waitcnt vmcnt(2)
    buffer_load_dwordx4 v3, s[44:47], s20 offen offset:1024 nt lds
    s_waitcnt vmcnt(2)
    buffer_load_dwordx4 v4, s[44:47], s20 offen offset:2048 nt lds
    s_waitcnt vmcnt(2)
    buffer_load_dwordx4 v5, s[44:47], s20 offen offset:3072 nt lds
    s_waitcnt vmcnt(2)
    ds_read_b128 v[96:99], v8 offset:0
    ds_read_b128 v[100:103], v9 offset:0
    ds_read_b128 v[104:107], v10 offset:0
    ds_read_b128 v[108:111], v11 offset:0
    s_waitcnt lgkmcnt(0)
    s_add_u32 s20, s14, 262144
    s_add_u32 m0, s15, 0
    s_nop 0
    buffer_load_dwordx4 v2, s[44:47], s20 offen offset:0 nt lds
    s_waitcnt vmcnt(2)
    buffer_load_dwordx4 v3, s[44:47], s20 offen offset:1024 nt lds
    s_waitcnt vmcnt(2)
    buffer_load_dwordx4 v4, s[44:47], s20 offen offset:2048 nt lds
    s_waitcnt vmcnt(2)
    buffer_load_dwordx4 v5, s[44:47], s20 offen offset:3072 nt lds
    s_barrier
    v_and_b32 v28, 3, v21
    v_lshlrev_b32 v28, 8, v28
    v_lshl_add_u32 v28, v20, 4, v28
    ds_read_b128 v[112:115], v28 offset:18432
    ds_read_b128 v[116:119], v28 offset:18496
    ds_read_b128 v[120:123], v28 offset:18560
    ds_read_b128 v[124:127], v28 offset:18624
    v_lshrrev_b32 v29, 2, v21
    v_cmp_eq_u32 s[24:25], 0, v29
    v_cmp_eq_u32 s[26:27], 1, v29
    v_cmp_eq_u32 s[28:29], 2, v29
    v_cmp_eq_u32 s[30:31], 3, v29
    s_waitcnt lgkmcnt(0)
    v_cndmask_b32 v128, 0, v112, s[24:25]
    v_cndmask_b32 v129, 0, v113, s[24:25]
    v_cndmask_b32 v130, 0, v114, s[24:25]
    v_cndmask_b32 v131, 0, v115, s[24:25]
    v_cndmask_b32 v132, 0, v116, s[24:25]
    v_cndmask_b32 v133, 0, v117, s[24:25]
    v_cndmask_b32 v134, 0, v118, s[24:25]
    v_cndmask_b32 v135, 0, v119, s[24:25]
    v_cndmask_b32 v136, 0, v120, s[24:25]
    v_cndmask_b32 v137, 0, v121, s[24:25]
    v_cndmask_b32 v138, 0, v122, s[24:25]
    v_cndmask_b32 v139, 0, v123, s[24:25]
    v_cndmask_b32 v140, 0, v124, s[24:25]
    v_cndmask_b32 v141, 0, v125, s[24:25]
    v_cndmask_b32 v142, 0, v126, s[24:25]
    v_cndmask_b32 v143, 0, v127, s[24:25]
    s_nop 1
    v_mfma_f32_16x16x32_bf16 v[144:147], v[32:35], v[128:131], 0
    v_mfma_f32_16x16x32_bf16 v[144:147], v[36:39], v[132:135], v[144:147]
    v_mfma_f32_16x16x32_bf16 v[144:147], v[40:43], v[136:139], v[144:147]
    v_mfma_f32_16x16x32_bf16 v[144:147], v[44:47], v[140:143], v[144:147]
    v_cndmask_b32 v128, 0, v112, s[26:27]
    v_cndmask_b32 v129, 0, v113, s[26:27]
    v_cndmask_b32 v130, 0, v114, s[26:27]
    v_cndmask_b32 v131, 0, v115, s[26:27]
    v_cndmask_b32 v132, 0, v116, s[26:27]
    v_cndmask_b32 v133, 0, v117, s[26:27]
    v_cndmask_b32 v134, 0, v118, s[26:27]
    v_cndmask_b32 v135, 0, v119, s[26:27]
    v_cndmask_b32 v136, 0, v120, s[26:27]
    v_cndmask_b32 v137, 0, v121, s[26:27]
    v_cndmask_b32 v138, 0, v122, s[26:27]
    v_cndmask_b32 v139, 0, v123, s[26:27]
    v_cndmask_b32 v140, 0, v124, s[26:27]
    v_cndmask_b32 v141, 0, v125, s[26:27]
    v_cndmask_b32 v142, 0, v126, s[26:27]
    v_cndmask_b32 v143, 0, v127, s[26:27]
    s_nop 1
    v_mfma_f32_16x16x32_bf16 v[144:147], v[48:51], v[128:131], v[144:147]
    v_mfma_f32_16x16x32_bf16 v[144:147], v[52:55], v[132:135], v[144:147]
    v_mfma_f32_16x16x32_bf16 v[144:147], v[56:59], v[136:139], v[144:147]
    v_mfma_f32_16x16x32_bf16 v[144:147], v[60:63], v[140:143], v[144:147]
    v_cndmask_b32 v128, 0, v112, s[28:29]
    v_cndmask_b32 v129, 0, v113, s[28:29]
    v_cndmask_b32 v130, 0, v114, s[28:29]
    v_cndmask_b32 v131, 0, v115, s[28:29]
    v_cndmask_b32 v132, 0, v116, s[28:29]
    v_cndmask_b32 v133, 0, v117, s[28:29]
    v_cndmask_b32 v134, 0, v118, s[28:29]
    v_cndmask_b32 v135, 0, v119, s[28:29]
    v_cndmask_b32 v136, 0, v120, s[28:29]
    v_cndmask_b32 v137, 0, v121, s[28:29]
    v_cndmask_b32 v138, 0, v122, s[28:29]
    v_cndmask_b32 v139, 0, v123, s[28:29]
    v_cndmask_b32 v140, 0, v124, s[28:29]
    v_cndmask_b32 v141, 0, v125, s[28:29]
    v_cndmask_b32 v142, 0, v126, s[28:29]
    v_cndmask_b32 v143, 0, v127, s[28:29]
    s_nop 1
    v_mfma_f32_16x16x32_bf16 v[144:147], v[64:67], v[128:131], v[144:147]
    v_mfma_f32_16x16x32_bf16 v[144:147], v[68:71], v[132:135], v[144:147]
    v_mfma_f32_16x16x32_bf16 v[144:147], v[72:75], v[136:139], v[144:147]
    v_mfma_f32_16x16x32_bf16 v[144:147], v[76:79], v[140:143], v[144:147]
    v_cndmask_b32 v128, 0, v112, s[30:31]
    v_cndmask_b32 v129, 0, v113, s[30:31]
    v_cndmask_b32 v130, 0, v114, s[30:31]
    v_cndmask_b32 v131, 0, v115, s[30:31]
    v_cndmask_b32 v132, 0, v116, s[30:31]
    v_cndmask_b32 v133, 0, v117, s[30:31]
    v_cndmask_b32 v134, 0, v118, s[30:31]
    v_cndmask_b32 v135, 0, v119, s[30:31]
    v_cndmask_b32 v136, 0, v120, s[30:31]
    v_cndmask_b32 v137, 0, v121, s[30:31]
    v_cndmask_b32 v138, 0, v122, s[30:31]
    v_cndmask_b32 v139, 0, v123, s[30:31]
    v_cndmask_b32 v140, 0, v124, s[30:31]
    v_cndmask_b32 v141, 0, v125, s[30:31]
    v_cndmask_b32 v142, 0, v126, s[30:31]
    v_cndmask_b32 v143, 0, v127, s[30:31]
    s_nop 1
    v_mfma_f32_16x16x32_bf16 v[144:147], v[80:83], v[128:131], v[144:147]
    v_mfma_f32_16x16x32_bf16 v[144:147], v[84:87], v[132:135], v[144:147]
    v_mfma_f32_16x16x32_bf16 v[144:147], v[88:91], v[136:139], v[144:147]
    v_mfma_f32_16x16x32_bf16 v[144:147], v[92:95], v[140:143], v[144:147]
    v_cndmask_b32 v128, 0, v112, s[24:25]
    v_cndmask_b32 v129, 0, v113, s[24:25]
    v_cndmask_b32 v130, 0, v114, s[24:25]
    v_cndmask_b32 v131, 0, v115, s[24:25]
    v_cndmask_b32 v132, 0, v116, s[24:25]
    v_cndmask_b32 v133, 0, v117, s[24:25]
    v_cndmask_b32 v134, 0, v118, s[24:25]
    v_cndmask_b32 v135, 0, v119, s[24:25]
    v_cndmask_b32 v136, 0, v120, s[24:25]
    v_cndmask_b32 v137, 0, v121, s[24:25]
    v_cndmask_b32 v138, 0, v122, s[24:25]
    v_cndmask_b32 v139, 0, v123, s[24:25]
    v_cndmask_b32 v140, 0, v124, s[24:25]
    v_cndmask_b32 v141, 0, v125, s[24:25]
    v_cndmask_b32 v142, 0, v126, s[24:25]
    v_cndmask_b32 v143, 0, v127, s[24:25]
    s_nop 1
    v_mfma_f32_16x16x32_bf16 v[148:151], v[96:99], v[128:131], 0
    v_mfma_f32_16x16x32_bf16 v[148:151], v[100:103], v[132:135], v[148:151]
    v_mfma_f32_16x16x32_bf16 v[148:151], v[104:107], v[136:139], v[148:151]
    v_mfma_f32_16x16x32_bf16 v[148:151], v[108:111], v[140:143], v[148:151]
    v_cndmask_b32 v128, 0, v112, s[26:27]
    v_cndmask_b32 v129, 0, v113, s[26:27]
    v_cndmask_b32 v130, 0, v114, s[26:27]
    v_cndmask_b32 v131, 0, v115, s[26:27]
    v_cndmask_b32 v132, 0, v116, s[26:27]
    v_cndmask_b32 v133, 0, v117, s[26:27]
    v_cndmask_b32 v134, 0, v118, s[26:27]
    v_cndmask_b32 v135, 0, v119, s[26:27]
    v_cndmask_b32 v136, 0, v120, s[26:27]
    v_cndmask_b32 v137, 0, v121, s[26:27]
    v_cndmask_b32 v138, 0, v122, s[26:27]
    v_cndmask_b32 v139, 0, v123, s[26:27]
    v_cndmask_b32 v140, 0, v124, s[26:27]
    v_cndmask_b32 v141, 0, v125, s[26:27]
    v_cndmask_b32 v142, 0, v126, s[26:27]
    v_cndmask_b32 v143, 0, v127, s[26:27]
    s_waitcnt vmcnt(12)
    ds_read_b128 v[32:35], v8 offset:4096
    ds_read_b128 v[36:39], v9 offset:4096
    ds_read_b128 v[40:43], v10 offset:4096
    ds_read_b128 v[44:47], v11 offset:4096
    s_waitcnt lgkmcnt(0)
    s_add_u32 s20, s14, 294912
    s_add_u32 m0, s15, 4096
    s_nop 0
    buffer_load_dwordx4 v2, s[44:47], s20 offen offset:0 nt lds
    buffer_load_dwordx4 v3, s[44:47], s20 offen offset:1024 nt lds
    buffer_load_dwordx4 v4, s[44:47], s20 offen offset:2048 nt lds
    buffer_load_dwordx4 v5, s[44:47], s20 offen offset:3072 nt lds
    v_mfma_f32_16x16x32_bf16 v[148:151], v[32:35], v[128:131], v[148:151]
    v_mfma_f32_16x16x32_bf16 v[148:151], v[36:39], v[132:135], v[148:151]
    v_mfma_f32_16x16x32_bf16 v[148:151], v[40:43], v[136:139], v[148:151]
    v_mfma_f32_16x16x32_bf16 v[148:151], v[44:47], v[140:143], v[148:151]
    v_cndmask_b32 v128, 0, v112, s[28:29]
    v_cndmask_b32 v129, 0, v113, s[28:29]
    v_cndmask_b32 v130, 0, v114, s[28:29]
    v_cndmask_b32 v131, 0, v115, s[28:29]
    v_cndmask_b32 v132, 0, v116, s[28:29]
    v_cndmask_b32 v133, 0, v117, s[28:29]
    v_cndmask_b32 v134, 0, v118, s[28:29]
    v_cndmask_b32 v135, 0, v119, s[28:29]
    v_cndmask_b32 v136, 0, v120, s[28:29]
    v_cndmask_b32 v137, 0, v121, s[28:29]
    v_cndmask_b32 v138, 0, v122, s[28:29]
    v_cndmask_b32 v139, 0, v123, s[28:29]
    v_cndmask_b32 v140, 0, v124, s[28:29]
    v_cndmask_b32 v141, 0, v125, s[28:29]
    v_cndmask_b32 v142, 0, v126, s[28:29]
    v_cndmask_b32 v143, 0, v127, s[28:29]
    s_waitcnt vmcnt(12)
    ds_read_b128 v[32:35], v8 offset:8192
    ds_read_b128 v[36:39], v9 offset:8192
    ds_read_b128 v[40:43], v10 offset:8192
    ds_read_b128 v[44:47], v11 offset:8192
    s_waitcnt lgkmcnt(0)
    s_add_u32 s20, s14, 327680
    s_add_u32 m0, s15, 8192
    s_nop 0
    buffer_load_dwordx4 v2, s[44:47], s20 offen offset:0 nt lds
    buffer_load_dwordx4 v3, s[44:47], s20 offen offset:1024 nt lds
    buffer_load_dwordx4 v4, s[44:47], s20 offen offset:2048 nt lds
    buffer_load_dwordx4 v5, s[44:47], s20 offen offset:3072 nt lds
    v_mfma_f32_16x16x32_bf16 v[148:151], v[32:35], v[128:131], v[148:151]
    v_mfma_f32_16x16x32_bf16 v[148:151], v[36:39], v[132:135], v[148:151]
    v_mfma_f32_16x16x32_bf16 v[148:151], v[40:43], v[136:139], v[148:151]
    v_mfma_f32_16x16x32_bf16 v[148:151], v[44:47], v[140:143], v[148:151]
    v_cndmask_b32 v128, 0, v112, s[30:31]
    v_cndmask_b32 v129, 0, v113, s[30:31]
    v_cndmask_b32 v130, 0, v114, s[30:31]
    v_cndmask_b32 v131, 0, v115, s[30:31]
    v_cndmask_b32 v132, 0, v116, s[30:31]
    v_cndmask_b32 v133, 0, v117, s[30:31]
    v_cndmask_b32 v134, 0, v118, s[30:31]
    v_cndmask_b32 v135, 0, v119, s[30:31]
    v_cndmask_b32 v136, 0, v120, s[30:31]
    v_cndmask_b32 v137, 0, v121, s[30:31]
    v_cndmask_b32 v138, 0, v122, s[30:31]
    v_cndmask_b32 v139, 0, v123, s[30:31]
    v_cndmask_b32 v140, 0, v124, s[30:31]
    v_cndmask_b32 v141, 0, v125, s[30:31]
    v_cndmask_b32 v142, 0, v126, s[30:31]
    v_cndmask_b32 v143, 0, v127, s[30:31]
    s_waitcnt vmcnt(12)
    ds_read_b128 v[32:35], v8 offset:12288
    ds_read_b128 v[36:39], v9 offset:12288
    ds_read_b128 v[40:43], v10 offset:12288
    ds_read_b128 v[44:47], v11 offset:12288
    s_waitcnt lgkmcnt(0)
    s_add_u32 s20, s14, 360448
    s_add_u32 m0, s15, 12288
    s_nop 0
    buffer_load_dwordx4 v2, s[44:47], s20 offen offset:0 nt lds
    buffer_load_dwordx4 v3, s[44:47], s20 offen offset:1024 nt lds
    buffer_load_dwordx4 v4, s[44:47], s20 offen offset:2048 nt lds
    buffer_load_dwordx4 v5, s[44:47], s20 offen offset:3072 nt lds
    v_mfma_f32_16x16x32_bf16 v[148:151], v[32:35], v[128:131], v[148:151]
    v_mfma_f32_16x16x32_bf16 v[148:151], v[36:39], v[132:135], v[148:151]
    v_mfma_f32_16x16x32_bf16 v[148:151], v[40:43], v[136:139], v[148:151]
    v_mfma_f32_16x16x32_bf16 v[148:151], v[44:47], v[140:143], v[148:151]
    v_cndmask_b32 v128, 0, v112, s[24:25]
    v_cndmask_b32 v129, 0, v113, s[24:25]
    v_cndmask_b32 v130, 0, v114, s[24:25]
    v_cndmask_b32 v131, 0, v115, s[24:25]
    v_cndmask_b32 v132, 0, v116, s[24:25]
    v_cndmask_b32 v133, 0, v117, s[24:25]
    v_cndmask_b32 v134, 0, v118, s[24:25]
    v_cndmask_b32 v135, 0, v119, s[24:25]
    v_cndmask_b32 v136, 0, v120, s[24:25]
    v_cndmask_b32 v137, 0, v121, s[24:25]
    v_cndmask_b32 v138, 0, v122, s[24:25]
    v_cndmask_b32 v139, 0, v123, s[24:25]
    v_cndmask_b32 v140, 0, v124, s[24:25]
    v_cndmask_b32 v141, 0, v125, s[24:25]
    v_cndmask_b32 v142, 0, v126, s[24:25]
    v_cndmask_b32 v143, 0, v127, s[24:25]
    s_waitcnt vmcnt(12)
    ds_read_b128 v[32:35], v8 offset:0
    ds_read_b128 v[36:39], v9 offset:0
    ds_read_b128 v[40:43], v10 offset:0
    ds_read_b128 v[44:47], v11 offset:0
    s_waitcnt lgkmcnt(0)
    s_add_u32 s20, s14, 393216
    s_add_u32 m0, s15, 0
    s_nop 0
    buffer_load_dwordx4 v2, s[44:47], s20 offen offset:0 nt lds
    buffer_load_dwordx4 v3, s[44:47], s20 offen offset:1024 nt lds
    buffer_load_dwordx4 v4, s[44:47], s20 offen offset:2048 nt lds
    buffer_load_dwordx4 v5, s[44:47], s20 offen offset:3072 nt lds
    v_mfma_f32_16x16x32_bf16 v[152:155], v[32:35], v[128:131], 0
    v_mfma_f32_16x16x32_bf16 v[152:155], v[36:39], v[132:135], v[152:155]
    v_mfma_f32_16x16x32_bf16 v[152:155], v[40:43], v[136:139], v[152:155]
    v_mfma_f32_16x16x32_bf16 v[152:155], v[44:47], v[140:143], v[152:155]
    v_cndmask_b32 v128, 0, v112, s[26:27]
    v_cndmask_b32 v129, 0, v113, s[26:27]
    v_cndmask_b32 v130, 0, v114, s[26:27]
    v_cndmask_b32 v131, 0, v115, s[26:27]
    v_cndmask_b32 v132, 0, v116, s[26:27]
    v_cndmask_b32 v133, 0, v117, s[26:27]
    v_cndmask_b32 v134, 0, v118, s[26:27]
    v_cndmask_b32 v135, 0, v119, s[26:27]
    v_cndmask_b32 v136, 0, v120, s[26:27]
    v_cndmask_b32 v137, 0, v121, s[26:27]
    v_cndmask_b32 v138, 0, v122, s[26:27]
    v_cndmask_b32 v139, 0, v123, s[26:27]
    v_cndmask_b32 v140, 0, v124, s[26:27]
    v_cndmask_b32 v141, 0, v125, s[26:27]
    v_cndmask_b32 v142, 0, v126, s[26:27]
    v_cndmask_b32 v143, 0, v127, s[26:27]
    s_waitcnt vmcnt(12)
    ds_read_b128 v[32:35], v8 offset:4096
    ds_read_b128 v[36:39], v9 offset:4096
    ds_read_b128 v[40:43], v10 offset:4096
    ds_read_b128 v[44:47], v11 offset:4096
    s_waitcnt lgkmcnt(0)
    s_add_u32 s20, s14, 425984
    s_add_u32 m0, s15, 4096
    s_nop 0
    buffer_load_dwordx4 v2, s[44:47], s20 offen offset:0 nt lds
    buffer_load_dwordx4 v3, s[44:47], s20 offen offset:1024 nt lds
    buffer_load_dwordx4 v4, s[44:47], s20 offen offset:2048 nt lds
    buffer_load_dwordx4 v5, s[44:47], s20 offen offset:3072 nt lds
    v_mfma_f32_16x16x32_bf16 v[152:155], v[32:35], v[128:131], v[152:155]
    v_mfma_f32_16x16x32_bf16 v[152:155], v[36:39], v[132:135], v[152:155]
    v_mfma_f32_16x16x32_bf16 v[152:155], v[40:43], v[136:139], v[152:155]
    v_mfma_f32_16x16x32_bf16 v[152:155], v[44:47], v[140:143], v[152:155]
    v_cndmask_b32 v128, 0, v112, s[28:29]
    v_cndmask_b32 v129, 0, v113, s[28:29]
    v_cndmask_b32 v130, 0, v114, s[28:29]
    v_cndmask_b32 v131, 0, v115, s[28:29]
    v_cndmask_b32 v132, 0, v116, s[28:29]
    v_cndmask_b32 v133, 0, v117, s[28:29]
    v_cndmask_b32 v134, 0, v118, s[28:29]
    v_cndmask_b32 v135, 0, v119, s[28:29]
    v_cndmask_b32 v136, 0, v120, s[28:29]
    v_cndmask_b32 v137, 0, v121, s[28:29]
    v_cndmask_b32 v138, 0, v122, s[28:29]
    v_cndmask_b32 v139, 0, v123, s[28:29]
    v_cndmask_b32 v140, 0, v124, s[28:29]
    v_cndmask_b32 v141, 0, v125, s[28:29]
    v_cndmask_b32 v142, 0, v126, s[28:29]
    v_cndmask_b32 v143, 0, v127, s[28:29]
    s_waitcnt vmcnt(12)
    ds_read_b128 v[32:35], v8 offset:8192
    ds_read_b128 v[36:39], v9 offset:8192
    ds_read_b128 v[40:43], v10 offset:8192
    ds_read_b128 v[44:47], v11 offset:8192
    s_waitcnt lgkmcnt(0)
    s_add_u32 s20, s14, 458752
    s_add_u32 m0, s15, 8192
    s_nop 0
    buffer_load_dwordx4 v2, s[44:47], s20 offen offset:0 nt lds
    buffer_load_dwordx4 v3, s[44:47], s20 offen offset:1024 nt lds
    buffer_load_dwordx4 v4, s[44:47], s20 offen offset:2048 nt lds
    buffer_load_dwordx4 v5, s[44:47], s20 offen offset:3072 nt lds
    v_mfma_f32_16x16x32_bf16 v[152:155], v[32:35], v[128:131], v[152:155]
    v_mfma_f32_16x16x32_bf16 v[152:155], v[36:39], v[132:135], v[152:155]
    v_mfma_f32_16x16x32_bf16 v[152:155], v[40:43], v[136:139], v[152:155]
    v_mfma_f32_16x16x32_bf16 v[152:155], v[44:47], v[140:143], v[152:155]
    v_cndmask_b32 v128, 0, v112, s[30:31]
    v_cndmask_b32 v129, 0, v113, s[30:31]
    v_cndmask_b32 v130, 0, v114, s[30:31]
    v_cndmask_b32 v131, 0, v115, s[30:31]
    v_cndmask_b32 v132, 0, v116, s[30:31]
    v_cndmask_b32 v133, 0, v117, s[30:31]
    v_cndmask_b32 v134, 0, v118, s[30:31]
    v_cndmask_b32 v135, 0, v119, s[30:31]
    v_cndmask_b32 v136, 0, v120, s[30:31]
    v_cndmask_b32 v137, 0, v121, s[30:31]
    v_cndmask_b32 v138, 0, v122, s[30:31]
    v_cndmask_b32 v139, 0, v123, s[30:31]
    v_cndmask_b32 v140, 0, v124, s[30:31]
    v_cndmask_b32 v141, 0, v125, s[30:31]
    v_cndmask_b32 v142, 0, v126, s[30:31]
    v_cndmask_b32 v143, 0, v127, s[30:31]
    s_waitcnt vmcnt(12)
    ds_read_b128 v[32:35], v8 offset:12288
    ds_read_b128 v[36:39], v9 offset:12288
    ds_read_b128 v[40:43], v10 offset:12288
    ds_read_b128 v[44:47], v11 offset:12288
    s_waitcnt lgkmcnt(0)
    s_add_u32 s20, s14, 491520
    s_add_u32 m0, s15, 12288
    s_nop 0
    buffer_load_dwordx4 v2, s[44:47], s20 offen offset:0 nt lds
    buffer_load_dwordx4 v3, s[44:47], s20 offen offset:1024 nt lds
    buffer_load_dwordx4 v4, s[44:47], s20 offen offset:2048 nt lds
    buffer_load_dwordx4 v5, s[44:47], s20 offen offset:3072 nt lds
    v_mfma_f32_16x16x32_bf16 v[152:155], v[32:35], v[128:131], v[152:155]
    v_mfma_f32_16x16x32_bf16 v[152:155], v[36:39], v[132:135], v[152:155]
    v_mfma_f32_16x16x32_bf16 v[152:155], v[40:43], v[136:139], v[152:155]
    v_mfma_f32_16x16x32_bf16 v[152:155], v[44:47], v[140:143], v[152:155]
    v_cndmask_b32 v128, 0, v112, s[24:25]
    v_cndmask_b32 v129, 0, v113, s[24:25]
    v_cndmask_b32 v130, 0, v114, s[24:25]
    v_cndmask_b32 v131, 0, v115, s[24:25]
    v_cndmask_b32 v132, 0, v116, s[24:25]
    v_cndmask_b32 v133, 0, v117, s[24:25]
    v_cndmask_b32 v134, 0, v118, s[24:25]
    v_cndmask_b32 v135, 0, v119, s[24:25]
    v_cndmask_b32 v136, 0, v120, s[24:25]
    v_cndmask_b32 v137, 0, v121, s[24:25]
    v_cndmask_b32 v138, 0, v122, s[24:25]
    v_cndmask_b32 v139, 0, v123, s[24:25]
    v_cndmask_b32 v140, 0, v124, s[24:25]
    v_cndmask_b32 v141, 0, v125, s[24:25]
    v_cndmask_b32 v142, 0, v126, s[24:25]
    v_cndmask_b32 v143, 0, v127, s[24:25]
    s_waitcnt vmcnt(12)
    ds_read_b128 v[32:35], v8 offset:0
    ds_read_b128 v[36:39], v9 offset:0
    ds_read_b128 v[40:43], v10 offset:0
    ds_read_b128 v[44:47], v11 offset:0
    s_waitcnt lgkmcnt(0)
    s_add_u32 s20, s14, 0
    s_add_u32 m0, s15, 0
    s_nop 0
    buffer_load_dwordx4 v6, s[48:51], s20 offen offset:0 nt lds
    buffer_load_dwordx4 v7, s[48:51], s20 offen offset:1024 nt lds
    buffer_load_dwordx4 v6, s[48:51], s20 offen offset:2048 nt lds
    buffer_load_dwordx4 v7, s[48:51], s20 offen offset:3072 nt lds
    v_mfma_f32_16x16x32_bf16 v[156:159], v[32:35], v[128:131], 0
    v_mfma_f32_16x16x32_bf16 v[156:159], v[36:39], v[132:135], v[156:159]
    v_mfma_f32_16x16x32_bf16 v[156:159], v[40:43], v[136:139], v[156:159]
    v_mfma_f32_16x16x32_bf16 v[156:159], v[44:47], v[140:143], v[156:159]
    v_cndmask_b32 v128, 0, v112, s[26:27]
    v_cndmask_b32 v129, 0, v113, s[26:27]
    v_cndmask_b32 v130, 0, v114, s[26:27]
    v_cndmask_b32 v131, 0, v115, s[26:27]
    v_cndmask_b32 v132, 0, v116, s[26:27]
    v_cndmask_b32 v133, 0, v117, s[26:27]
    v_cndmask_b32 v134, 0, v118, s[26:27]
    v_cndmask_b32 v135, 0, v119, s[26:27]
    v_cndmask_b32 v136, 0, v120, s[26:27]
    v_cndmask_b32 v137, 0, v121, s[26:27]
    v_cndmask_b32 v138, 0, v122, s[26:27]
    v_cndmask_b32 v139, 0, v123, s[26:27]
    v_cndmask_b32 v140, 0, v124, s[26:27]
    v_cndmask_b32 v141, 0, v125, s[26:27]
    v_cndmask_b32 v142, 0, v126, s[26:27]
    v_cndmask_b32 v143, 0, v127, s[26:27]
    s_waitcnt vmcnt(12)
    ds_read_b128 v[32:35], v8 offset:4096
    ds_read_b128 v[36:39], v9 offset:4096
    ds_read_b128 v[40:43], v10 offset:4096
    ds_read_b128 v[44:47], v11 offset:4096
    s_waitcnt lgkmcnt(0)
    s_add_u32 s20, s14, 32768
    s_add_u32 m0, s15, 4096
    s_nop 0
    buffer_load_dwordx4 v6, s[48:51], s20 offen offset:0 nt lds
    buffer_load_dwordx4 v7, s[48:51], s20 offen offset:1024 nt lds
    buffer_load_dwordx4 v6, s[48:51], s20 offen offset:2048 nt lds
    buffer_load_dwordx4 v7, s[48:51], s20 offen offset:3072 nt lds
    v_mfma_f32_16x16x32_bf16 v[156:159], v[32:35], v[128:131], v[156:159]
    v_mfma_f32_16x16x32_bf16 v[156:159], v[36:39], v[132:135], v[156:159]
    v_mfma_f32_16x16x32_bf16 v[156:159], v[40:43], v[136:139], v[156:159]
    v_mfma_f32_16x16x32_bf16 v[156:159], v[44:47], v[140:143], v[156:159]
    v_cndmask_b32 v128, 0, v112, s[28:29]
    v_cndmask_b32 v129, 0, v113, s[28:29]
    v_cndmask_b32 v130, 0, v114, s[28:29]
    v_cndmask_b32 v131, 0, v115, s[28:29]
    v_cndmask_b32 v132, 0, v116, s[28:29]
    v_cndmask_b32 v133, 0, v117, s[28:29]
    v_cndmask_b32 v134, 0, v118, s[28:29]
    v_cndmask_b32 v135, 0, v119, s[28:29]
    v_cndmask_b32 v136, 0, v120, s[28:29]
    v_cndmask_b32 v137, 0, v121, s[28:29]
    v_cndmask_b32 v138, 0, v122, s[28:29]
    v_cndmask_b32 v139, 0, v123, s[28:29]
    v_cndmask_b32 v140, 0, v124, s[28:29]
    v_cndmask_b32 v141, 0, v125, s[28:29]
    v_cndmask_b32 v142, 0, v126, s[28:29]
    v_cndmask_b32 v143, 0, v127, s[28:29]
    s_waitcnt vmcnt(12)
    ds_read_b128 v[32:35], v8 offset:8192
    ds_read_b128 v[36:39], v9 offset:8192
    ds_read_b128 v[40:43], v10 offset:8192
    ds_read_b128 v[44:47], v11 offset:8192
    s_waitcnt lgkmcnt(0)
    s_add_u32 s20, s14, 65536
    s_add_u32 m0, s15, 8192
    s_nop 0
    buffer_load_dwordx4 v6, s[48:51], s20 offen offset:0 nt lds
    buffer_load_dwordx4 v7, s[48:51], s20 offen offset:1024 nt lds
    buffer_load_dwordx4 v6, s[48:51], s20 offen offset:2048 nt lds
    buffer_load_dwordx4 v7, s[48:51], s20 offen offset:3072 nt lds
    v_mfma_f32_16x16x32_bf16 v[156:159], v[32:35], v[128:131], v[156:159]
    v_mfma_f32_16x16x32_bf16 v[156:159], v[36:39], v[132:135], v[156:159]
    v_mfma_f32_16x16x32_bf16 v[156:159], v[40:43], v[136:139], v[156:159]
    v_mfma_f32_16x16x32_bf16 v[156:159], v[44:47], v[140:143], v[156:159]
    v_cndmask_b32 v128, 0, v112, s[30:31]
    v_cndmask_b32 v129, 0, v113, s[30:31]
    v_cndmask_b32 v130, 0, v114, s[30:31]
    v_cndmask_b32 v131, 0, v115, s[30:31]
    v_cndmask_b32 v132, 0, v116, s[30:31]
    v_cndmask_b32 v133, 0, v117, s[30:31]
    v_cndmask_b32 v134, 0, v118, s[30:31]
    v_cndmask_b32 v135, 0, v119, s[30:31]
    v_cndmask_b32 v136, 0, v120, s[30:31]
    v_cndmask_b32 v137, 0, v121, s[30:31]
    v_cndmask_b32 v138, 0, v122, s[30:31]
    v_cndmask_b32 v139, 0, v123, s[30:31]
    v_cndmask_b32 v140, 0, v124, s[30:31]
    v_cndmask_b32 v141, 0, v125, s[30:31]
    v_cndmask_b32 v142, 0, v126, s[30:31]
    v_cndmask_b32 v143, 0, v127, s[30:31]
    s_waitcnt vmcnt(12)
    ds_read_b128 v[32:35], v8 offset:12288
    ds_read_b128 v[36:39], v9 offset:12288
    ds_read_b128 v[40:43], v10 offset:12288
    ds_read_b128 v[44:47], v11 offset:12288
    s_waitcnt lgkmcnt(0)
    s_add_u32 s20, s14, 98304
    s_add_u32 m0, s15, 12288
    s_nop 0
    buffer_load_dwordx4 v6, s[48:51], s20 offen offset:0 nt lds
    buffer_load_dwordx4 v7, s[48:51], s20 offen offset:1024 nt lds
    buffer_load_dwordx4 v6, s[48:51], s20 offen offset:2048 nt lds
    buffer_load_dwordx4 v7, s[48:51], s20 offen offset:3072 nt lds
    v_mfma_f32_16x16x32_bf16 v[156:159], v[32:35], v[128:131], v[156:159]
    v_mfma_f32_16x16x32_bf16 v[156:159], v[36:39], v[132:135], v[156:159]
    v_mfma_f32_16x16x32_bf16 v[156:159], v[40:43], v[136:139], v[156:159]
    v_mfma_f32_16x16x32_bf16 v[156:159], v[44:47], v[140:143], v[156:159]
    s_nop 7
    s_nop 1
    v_cvt_pk_bf16_f32 v28, v144, v145
    v_lshlrev_b32 v144, 16, v28
    v_and_b32 v145, 0xffff0000, v28
    v_cvt_pk_bf16_f32 v28, v146, v147
    v_lshlrev_b32 v146, 16, v28
    v_and_b32 v147, 0xffff0000, v28
    v_cvt_pk_bf16_f32 v28, v148, v149
    v_lshlrev_b32 v148, 16, v28
    v_and_b32 v149, 0xffff0000, v28
    v_cvt_pk_bf16_f32 v28, v150, v151
    v_lshlrev_b32 v150, 16, v28
    v_and_b32 v151, 0xffff0000, v28
    v_cvt_pk_bf16_f32 v28, v152, v153
    v_lshlrev_b32 v152, 16, v28
    v_and_b32 v153, 0xffff0000, v28
    v_cvt_pk_bf16_f32 v28, v154, v155
    v_lshlrev_b32 v154, 16, v28
    v_and_b32 v155, 0xffff0000, v28
    v_cvt_pk_bf16_f32 v28, v156, v157
    v_lshlrev_b32 v156, 16, v28
    v_and_b32 v157, 0xffff0000, v28
    v_cvt_pk_bf16_f32 v28, v158, v159
    v_lshlrev_b32 v158, 16, v28
    v_and_b32 v159, 0xffff0000, v28
    v_mul_f32 v144, 0x3db504f3, v144
    v_mul_f32 v145, 0x3db504f3, v145
    v_mul_f32 v146, 0x3db504f3, v146
    v_mul_f32 v147, 0x3db504f3, v147
    v_mul_f32 v148, 0x3db504f3, v148
    v_mul_f32 v149, 0x3db504f3, v149
    v_mul_f32 v150, 0x3db504f3, v150
    v_mul_f32 v151, 0x3db504f3, v151
    v_mul_f32 v152, 0x3db504f3, v152
    v_mul_f32 v153, 0x3db504f3, v153
    v_mul_f32 v154, 0x3db504f3, v154
    v_mul_f32 v155, 0x3db504f3, v155
    v_mul_f32 v156, 0x3db504f3, v156
    v_mul_f32 v157, 0x3db504f3, v157
    v_mul_f32 v158, 0x3db504f3, v158
    v_mul_f32 v159, 0x3db504f3, v159
    v_cvt_pk_bf16_f32 v28, v144, v145
    v_lshlrev_b32 v144, 16, v28
    v_and_b32 v145, 0xffff0000, v28
    v_cvt_pk_bf16_f32 v28, v146, v147
    v_lshlrev_b32 v146, 16, v28
    v_and_b32 v147, 0xffff0000, v28
    v_cvt_pk_bf16_f32 v28, v148, v149
    v_lshlrev_b32 v148, 16, v28
    v_and_b32 v149, 0xffff0000, v28
    v_cvt_pk_bf16_f32 v28, v150, v151
    v_lshlrev_b32 v150, 16, v28
    v_and_b32 v151, 0xffff0000, v28
    v_cvt_pk_bf16_f32 v28, v152, v153
    v_lshlrev_b32 v152, 16, v28
    v_and_b32 v153, 0xffff0000, v28
    v_cvt_pk_bf16_f32 v28, v154, v155
    v_lshlrev_b32 v154, 16, v28
    v_and_b32 v155, 0xffff0000, v28
    v_cvt_pk_bf16_f32 v28, v156, v157
    v_lshlrev_b32 v156, 16, v28
    v_and_b32 v157, 0xffff0000, v28
    v_cvt_pk_bf16_f32 v28, v158, v159
    v_lshlrev_b32 v158, 16, v28
    v_and_b32 v159, 0xffff0000, v28
    v_max3_f32 v52, v144, v145, v146
    v_max3_f32 v52, v52, v147, v148
    v_max3_f32 v52, v52, v149, v150
    v_max3_f32 v52, v52, v151, v152
    v_max3_f32 v52, v52, v153, v154
    v_max3_f32 v52, v52, v155, v156
    v_max3_f32 v52, v52, v157, v158
    v_max_f32 v52, v52, v159
    s_nop 1
    v_max_f32_dpp v52, v52, v52 row_ror:4 row_mask:0xf bank_mask:0xf
    s_nop 1
    v_max_f32_dpp v52, v52, v52 row_ror:8 row_mask:0xf bank_mask:0xf
    v_mov_b32 v28, v52
    s_nop 1
    v_permlane16_swap_b32 v52, v28
    s_nop 1
    v_max_f32 v52, v52, v28
    v_mov_b32 v28, v52
    s_nop 1
    v_permlane32_swap_b32 v52, v28
    s_nop 1
    v_max_f32 v52, v52, v28
    s_mov_b32 s16, 0x3fb8aa3b
    v_sub_f32 v144, v144, v52
    v_sub_f32 v145, v145, v52
    v_sub_f32 v146, v146, v52
    v_sub_f32 v147, v147, v52
    v_sub_f32 v148, v148, v52
    v_sub_f32 v149, v149, v52
    v_sub_f32 v150, v150, v52
    v_sub_f32 v151, v151, v52
    v_sub_f32 v152, v152, v52
    v_sub_f32 v153, v153, v52
    v_sub_f32 v154, v154, v52
    v_sub_f32 v155, v155, v52
    v_sub_f32 v156, v156, v52
    v_sub_f32 v157, v157, v52
    v_sub_f32 v158, v158, v52
    v_sub_f32 v159, v159, v52
    v_mul_f32 v144, s16, v144
    v_mul_f32 v145, s16, v145
    v_mul_f32 v146, s16, v146
    v_mul_f32 v147, s16, v147
    v_mul_f32 v148, s16, v148
    v_mul_f32 v149, s16, v149
    v_mul_f32 v150, s16, v150
    v_mul_f32 v151, s16, v151
    v_mul_f32 v152, s16, v152
    v_mul_f32 v153, s16, v153
    v_mul_f32 v154, s16, v154
    v_mul_f32 v155, s16, v155
    v_mul_f32 v156, s16, v156
    v_mul_f32 v157, s16, v157
    v_mul_f32 v158, s16, v158
    v_mul_f32 v159, s16, v159
    v_exp_f32 v144, v144
    v_exp_f32 v145, v145
    v_exp_f32 v146, v146
    v_exp_f32 v147, v147
    v_exp_f32 v148, v148
    v_exp_f32 v149, v149
    v_exp_f32 v150, v150
    v_exp_f32 v151, v151
    v_exp_f32 v152, v152
    v_exp_f32 v153, v153
    v_exp_f32 v154, v154
    v_exp_f32 v155, v155
    v_exp_f32 v156, v156
    v_exp_f32 v157, v157
    v_exp_f32 v158, v158
    v_exp_f32 v159, v159
    s_nop 0
    v_add_f32 v53, v144, v145
    v_add_f32 v53, v53, v146
    v_add_f32 v53, v53, v147
    v_add_f32 v53, v53, v148
    v_add_f32 v53, v53, v149
    v_add_f32 v53, v53, v150
    v_add_f32 v53, v53, v151
    v_add_f32 v53, v53, v152
    v_add_f32 v53, v53, v153
    v_add_f32 v53, v53, v154
    v_add_f32 v53, v53, v155
    v_add_f32 v53, v53, v156
    v_add_f32 v53, v53, v157
    v_add_f32 v53, v53, v158
    v_add_f32 v53, v53, v159
    s_nop 1
    v_add_f32_dpp v53, v53, v53 row_ror:4 row_mask:0xf bank_mask:0xf
    s_nop 1
    v_add_f32_dpp v53, v53, v53 row_ror:8 row_mask:0xf bank_mask:0xf
    v_mov_b32 v28, v53
    s_nop 1
    v_permlane16_swap_b32 v53, v28
    s_nop 1
    v_add_f32 v53, v53, v28
    v_mov_b32 v28, v53
    s_nop 1
    v_permlane32_swap_b32 v53, v28
    s_nop 1
    v_add_f32 v53, v53, v28
    v_cvt_pk_bf16_f32 v112, v144, v145
    v_cvt_pk_bf16_f32 v113, v146, v147
    v_cvt_pk_bf16_f32 v114, v148, v149
    v_cvt_pk_bf16_f32 v115, v150, v151
    v_cvt_pk_bf16_f32 v116, v152, v153
    v_cvt_pk_bf16_f32 v117, v154, v155
    v_cvt_pk_bf16_f32 v118, v156, v157
    v_cvt_pk_bf16_f32 v119, v158, v159
    s_waitcnt vmcnt(12)
    ds_read_b64_tr_b16 v[32:33], v12 offset:0
    ds_read_b64_tr_b16 v[34:35], v13 offset:0
    ds_read_b64_tr_b16 v[36:37], v14 offset:0
    ds_read_b64_tr_b16 v[38:39], v15 offset:0
    ds_read_b64_tr_b16 v[40:41], v16 offset:0
    ds_read_b64_tr_b16 v[42:43], v17 offset:0
    ds_read_b64_tr_b16 v[44:45], v18 offset:0
    ds_read_b64_tr_b16 v[46:47], v19 offset:0
    v_mov_b32 v48, v112
    v_mov_b32 v49, v113
    s_waitcnt lgkmcnt(0)
    s_add_u32 s20, s14, 131072
    s_add_u32 m0, s15, 0
    s_nop 0
    buffer_load_dwordx4 v6, s[48:51], s20 offen offset:0 nt lds
    buffer_load_dwordx4 v7, s[48:51], s20 offen offset:1024 nt lds
    buffer_load_dwordx4 v6, s[48:51], s20 offen offset:2048 nt lds
    buffer_load_dwordx4 v7, s[48:51], s20 offen offset:3072 nt lds
    v_mfma_f32_16x16x16_bf16 v[56:59], v[48:49], v[32:33], 0
    v_mfma_f32_16x16x16_bf16 v[60:63], v[48:49], v[34:35], 0
    v_mfma_f32_16x16x16_bf16 v[64:67], v[48:49], v[36:37], 0
    v_mfma_f32_16x16x16_bf16 v[68:71], v[48:49], v[38:39], 0
    v_mfma_f32_16x16x16_bf16 v[72:75], v[48:49], v[40:41], 0
    v_mfma_f32_16x16x16_bf16 v[76:79], v[48:49], v[42:43], 0
    v_mfma_f32_16x16x16_bf16 v[80:83], v[48:49], v[44:45], 0
    v_mfma_f32_16x16x16_bf16 v[84:87], v[48:49], v[46:47], 0
    s_waitcnt vmcnt(12)
    ds_read_b64_tr_b16 v[32:33], v12 offset:4096
    ds_read_b64_tr_b16 v[34:35], v13 offset:4096
    ds_read_b64_tr_b16 v[36:37], v14 offset:4096
    ds_read_b64_tr_b16 v[38:39], v15 offset:4096
    ds_read_b64_tr_b16 v[40:41], v16 offset:4096
    ds_read_b64_tr_b16 v[42:43], v17 offset:4096
    ds_read_b64_tr_b16 v[44:45], v18 offset:4096
    ds_read_b64_tr_b16 v[46:47], v19 offset:4096
    v_mov_b32_dpp v50, v112 row_shl:4 row_mask:0xf bank_mask:0xf
    v_mov_b32_dpp v51, v113 row_shl:4 row_mask:0xf bank_mask:0xf
    s_waitcnt lgkmcnt(0)
    s_add_u32 s20, s14, 163840
    s_add_u32 m0, s15, 4096
    s_nop 0
    buffer_load_dwordx4 v6, s[48:51], s20 offen offset:0 nt lds
    buffer_load_dwordx4 v7, s[48:51], s20 offen offset:1024 nt lds
    buffer_load_dwordx4 v6, s[48:51], s20 offen offset:2048 nt lds
    buffer_load_dwordx4 v7, s[48:51], s20 offen offset:3072 nt lds
    v_mfma_f32_16x16x16_bf16 v[56:59], v[50:51], v[32:33], v[56:59]
    v_mfma_f32_16x16x16_bf16 v[60:63], v[50:51], v[34:35], v[60:63]
    v_mfma_f32_16x16x16_bf16 v[64:67], v[50:51], v[36:37], v[64:67]
    v_mfma_f32_16x16x16_bf16 v[68:71], v[50:51], v[38:39], v[68:71]
    v_mfma_f32_16x16x16_bf16 v[72:75], v[50:51], v[40:41], v[72:75]
    v_mfma_f32_16x16x16_bf16 v[76:79], v[50:51], v[42:43], v[76:79]
    v_mfma_f32_16x16x16_bf16 v[80:83], v[50:51], v[44:45], v[80:83]
    v_mfma_f32_16x16x16_bf16 v[84:87], v[50:51], v[46:47], v[84:87]
    s_waitcnt vmcnt(12)
    ds_read_b64_tr_b16 v[32:33], v12 offset:8192
    ds_read_b64_tr_b16 v[34:35], v13 offset:8192
    ds_read_b64_tr_b16 v[36:37], v14 offset:8192
    ds_read_b64_tr_b16 v[38:39], v15 offset:8192
    ds_read_b64_tr_b16 v[40:41], v16 offset:8192
    ds_read_b64_tr_b16 v[42:43], v17 offset:8192
    ds_read_b64_tr_b16 v[44:45], v18 offset:8192
    ds_read_b64_tr_b16 v[46:47], v19 offset:8192
    v_mov_b32_dpp v48, v112 row_shl:8 row_mask:0xf bank_mask:0xf
    v_mov_b32_dpp v49, v113 row_shl:8 row_mask:0xf bank_mask:0xf
    s_waitcnt lgkmcnt(0)
    s_add_u32 s20, s14, 196608
    s_add_u32 m0, s15, 8192
    s_nop 0
    buffer_load_dwordx4 v6, s[48:51], s20 offen offset:0 nt lds
    buffer_load_dwordx4 v7, s[48:51], s20 offen offset:1024 nt lds
    buffer_load_dwordx4 v6, s[48:51], s20 offen offset:2048 nt lds
    buffer_load_dwordx4 v7, s[48:51], s20 offen offset:3072 nt lds
    v_mfma_f32_16x16x16_bf16 v[56:59], v[48:49], v[32:33], v[56:59]
    v_mfma_f32_16x16x16_bf16 v[60:63], v[48:49], v[34:35], v[60:63]
    v_mfma_f32_16x16x16_bf16 v[64:67], v[48:49], v[36:37], v[64:67]
    v_mfma_f32_16x16x16_bf16 v[68:71], v[48:49], v[38:39], v[68:71]
    v_mfma_f32_16x16x16_bf16 v[72:75], v[48:49], v[40:41], v[72:75]
    v_mfma_f32_16x16x16_bf16 v[76:79], v[48:49], v[42:43], v[76:79]
    v_mfma_f32_16x16x16_bf16 v[80:83], v[48:49], v[44:45], v[80:83]
    v_mfma_f32_16x16x16_bf16 v[84:87], v[48:49], v[46:47], v[84:87]
    s_waitcnt vmcnt(12)
    ds_read_b64_tr_b16 v[32:33], v12 offset:12288
    ds_read_b64_tr_b16 v[34:35], v13 offset:12288
    ds_read_b64_tr_b16 v[36:37], v14 offset:12288
    ds_read_b64_tr_b16 v[38:39], v15 offset:12288
    ds_read_b64_tr_b16 v[40:41], v16 offset:12288
    ds_read_b64_tr_b16 v[42:43], v17 offset:12288
    ds_read_b64_tr_b16 v[44:45], v18 offset:12288
    ds_read_b64_tr_b16 v[46:47], v19 offset:12288
    v_mov_b32_dpp v50, v112 row_shl:12 row_mask:0xf bank_mask:0xf
    v_mov_b32_dpp v51, v113 row_shl:12 row_mask:0xf bank_mask:0xf
    s_waitcnt lgkmcnt(0)
    s_add_u32 s20, s14, 229376
    s_add_u32 m0, s15, 12288
    s_nop 0
    buffer_load_dwordx4 v6, s[48:51], s20 offen offset:0 nt lds
    buffer_load_dwordx4 v7, s[48:51], s20 offen offset:1024 nt lds
    buffer_load_dwordx4 v6, s[48:51], s20 offen offset:2048 nt lds
    buffer_load_dwordx4 v7, s[48:51], s20 offen offset:3072 nt lds
    v_mfma_f32_16x16x16_bf16 v[56:59], v[50:51], v[32:33], v[56:59]
    v_mfma_f32_16x16x16_bf16 v[60:63], v[50:51], v[34:35], v[60:63]
    v_mfma_f32_16x16x16_bf16 v[64:67], v[50:51], v[36:37], v[64:67]
    v_mfma_f32_16x16x16_bf16 v[68:71], v[50:51], v[38:39], v[68:71]
    v_mfma_f32_16x16x16_bf16 v[72:75], v[50:51], v[40:41], v[72:75]
    v_mfma_f32_16x16x16_bf16 v[76:79], v[50:51], v[42:43], v[76:79]
    v_mfma_f32_16x16x16_bf16 v[80:83], v[50:51], v[44:45], v[80:83]
    v_mfma_f32_16x16x16_bf16 v[84:87], v[50:51], v[46:47], v[84:87]
    s_waitcnt vmcnt(12)
    ds_read_b64_tr_b16 v[32:33], v12 offset:0
    ds_read_b64_tr_b16 v[34:35], v13 offset:0
    ds_read_b64_tr_b16 v[36:37], v14 offset:0
    ds_read_b64_tr_b16 v[38:39], v15 offset:0
    ds_read_b64_tr_b16 v[40:41], v16 offset:0
    ds_read_b64_tr_b16 v[42:43], v17 offset:0
    ds_read_b64_tr_b16 v[44:45], v18 offset:0
    ds_read_b64_tr_b16 v[46:47], v19 offset:0
    v_mov_b32 v48, v114
    v_mov_b32 v49, v115
    s_waitcnt lgkmcnt(0)
    s_add_u32 s20, s14, 262144
    s_add_u32 m0, s15, 0
    s_nop 0
    buffer_load_dwordx4 v6, s[48:51], s20 offen offset:0 nt lds
    buffer_load_dwordx4 v7, s[48:51], s20 offen offset:1024 nt lds
    buffer_load_dwordx4 v6, s[48:51], s20 offen offset:2048 nt lds
    buffer_load_dwordx4 v7, s[48:51], s20 offen offset:3072 nt lds
    v_mfma_f32_16x16x16_bf16 v[56:59], v[48:49], v[32:33], v[56:59]
    v_mfma_f32_16x16x16_bf16 v[60:63], v[48:49], v[34:35], v[60:63]
    v_mfma_f32_16x16x16_bf16 v[64:67], v[48:49], v[36:37], v[64:67]
    v_mfma_f32_16x16x16_bf16 v[68:71], v[48:49], v[38:39], v[68:71]
    v_mfma_f32_16x16x16_bf16 v[72:75], v[48:49], v[40:41], v[72:75]
    v_mfma_f32_16x16x16_bf16 v[76:79], v[48:49], v[42:43], v[76:79]
    v_mfma_f32_16x16x16_bf16 v[80:83], v[48:49], v[44:45], v[80:83]
    v_mfma_f32_16x16x16_bf16 v[84:87], v[48:49], v[46:47], v[84:87]
    s_waitcnt vmcnt(12)
    ds_read_b64_tr_b16 v[32:33], v12 offset:4096
    ds_read_b64_tr_b16 v[34:35], v13 offset:4096
    ds_read_b64_tr_b16 v[36:37], v14 offset:4096
    ds_read_b64_tr_b16 v[38:39], v15 offset:4096
    ds_read_b64_tr_b16 v[40:41], v16 offset:4096
    ds_read_b64_tr_b16 v[42:43], v17 offset:4096
    ds_read_b64_tr_b16 v[44:45], v18 offset:4096
    ds_read_b64_tr_b16 v[46:47], v19 offset:4096
    v_mov_b32_dpp v50, v114 row_shl:4 row_mask:0xf bank_mask:0xf
    v_mov_b32_dpp v51, v115 row_shl:4 row_mask:0xf bank_mask:0xf
    s_waitcnt lgkmcnt(0)
    s_add_u32 s20, s14, 294912
    s_add_u32 m0, s15, 4096
    s_nop 0
    buffer_load_dwordx4 v6, s[48:51], s20 offen offset:0 nt lds
    buffer_load_dwordx4 v7, s[48:51], s20 offen offset:1024 nt lds
    buffer_load_dwordx4 v6, s[48:51], s20 offen offset:2048 nt lds
    buffer_load_dwordx4 v7, s[48:51], s20 offen offset:3072 nt lds
    v_mfma_f32_16x16x16_bf16 v[56:59], v[50:51], v[32:33], v[56:59]
    v_mfma_f32_16x16x16_bf16 v[60:63], v[50:51], v[34:35], v[60:63]
    v_mfma_f32_16x16x16_bf16 v[64:67], v[50:51], v[36:37], v[64:67]
    v_mfma_f32_16x16x16_bf16 v[68:71], v[50:51], v[38:39], v[68:71]
    v_mfma_f32_16x16x16_bf16 v[72:75], v[50:51], v[40:41], v[72:75]
    v_mfma_f32_16x16x16_bf16 v[76:79], v[50:51], v[42:43], v[76:79]
    v_mfma_f32_16x16x16_bf16 v[80:83], v[50:51], v[44:45], v[80:83]
    v_mfma_f32_16x16x16_bf16 v[84:87], v[50:51], v[46:47], v[84:87]
    s_waitcnt vmcnt(12)
    ds_read_b64_tr_b16 v[32:33], v12 offset:8192
    ds_read_b64_tr_b16 v[34:35], v13 offset:8192
    ds_read_b64_tr_b16 v[36:37], v14 offset:8192
    ds_read_b64_tr_b16 v[38:39], v15 offset:8192
    ds_read_b64_tr_b16 v[40:41], v16 offset:8192
    ds_read_b64_tr_b16 v[42:43], v17 offset:8192
    ds_read_b64_tr_b16 v[44:45], v18 offset:8192
    ds_read_b64_tr_b16 v[46:47], v19 offset:8192
    v_mov_b32_dpp v48, v114 row_shl:8 row_mask:0xf bank_mask:0xf
    v_mov_b32_dpp v49, v115 row_shl:8 row_mask:0xf bank_mask:0xf
    s_waitcnt lgkmcnt(0)
    s_add_u32 s20, s14, 327680
    s_add_u32 m0, s15, 8192
    s_nop 0
    buffer_load_dwordx4 v6, s[48:51], s20 offen offset:0 nt lds
    buffer_load_dwordx4 v7, s[48:51], s20 offen offset:1024 nt lds
    buffer_load_dwordx4 v6, s[48:51], s20 offen offset:2048 nt lds
    buffer_load_dwordx4 v7, s[48:51], s20 offen offset:3072 nt lds
    v_mfma_f32_16x16x16_bf16 v[56:59], v[48:49], v[32:33], v[56:59]
    v_mfma_f32_16x16x16_bf16 v[60:63], v[48:49], v[34:35], v[60:63]
    v_mfma_f32_16x16x16_bf16 v[64:67], v[48:49], v[36:37], v[64:67]
    v_mfma_f32_16x16x16_bf16 v[68:71], v[48:49], v[38:39], v[68:71]
    v_mfma_f32_16x16x16_bf16 v[72:75], v[48:49], v[40:41], v[72:75]
    v_mfma_f32_16x16x16_bf16 v[76:79], v[48:49], v[42:43], v[76:79]
    v_mfma_f32_16x16x16_bf16 v[80:83], v[48:49], v[44:45], v[80:83]
    v_mfma_f32_16x16x16_bf16 v[84:87], v[48:49], v[46:47], v[84:87]
    s_waitcnt vmcnt(12)
    ds_read_b64_tr_b16 v[32:33], v12 offset:12288
    ds_read_b64_tr_b16 v[34:35], v13 offset:12288
    ds_read_b64_tr_b16 v[36:37], v14 offset:12288
    ds_read_b64_tr_b16 v[38:39], v15 offset:12288
    ds_read_b64_tr_b16 v[40:41], v16 offset:12288
    ds_read_b64_tr_b16 v[42:43], v17 offset:12288
    ds_read_b64_tr_b16 v[44:45], v18 offset:12288
    ds_read_b64_tr_b16 v[46:47], v19 offset:12288
    v_mov_b32_dpp v50, v114 row_shl:12 row_mask:0xf bank_mask:0xf
    v_mov_b32_dpp v51, v115 row_shl:12 row_mask:0xf bank_mask:0xf
    s_waitcnt lgkmcnt(0)
    s_add_u32 s20, s14, 360448
    s_add_u32 m0, s15, 12288
    s_nop 0
    buffer_load_dwordx4 v6, s[48:51], s20 offen offset:0 nt lds
    buffer_load_dwordx4 v7, s[48:51], s20 offen offset:1024 nt lds
    buffer_load_dwordx4 v6, s[48:51], s20 offen offset:2048 nt lds
    buffer_load_dwordx4 v7, s[48:51], s20 offen offset:3072 nt lds
    v_mfma_f32_16x16x16_bf16 v[56:59], v[50:51], v[32:33], v[56:59]
    v_mfma_f32_16x16x16_bf16 v[60:63], v[50:51], v[34:35], v[60:63]
    v_mfma_f32_16x16x16_bf16 v[64:67], v[50:51], v[36:37], v[64:67]
    v_mfma_f32_16x16x16_bf16 v[68:71], v[50:51], v[38:39], v[68:71]
    v_mfma_f32_16x16x16_bf16 v[72:75], v[50:51], v[40:41], v[72:75]
    v_mfma_f32_16x16x16_bf16 v[76:79], v[50:51], v[42:43], v[76:79]
    v_mfma_f32_16x16x16_bf16 v[80:83], v[50:51], v[44:45], v[80:83]
    v_mfma_f32_16x16x16_bf16 v[84:87], v[50:51], v[46:47], v[84:87]
    s_waitcnt vmcnt(12)
    ds_read_b64_tr_b16 v[32:33], v12 offset:0
    ds_read_b64_tr_b16 v[34:35], v13 offset:0
    ds_read_b64_tr_b16 v[36:37], v14 offset:0
    ds_read_b64_tr_b16 v[38:39], v15 offset:0
    ds_read_b64_tr_b16 v[40:41], v16 offset:0
    ds_read_b64_tr_b16 v[42:43], v17 offset:0
    ds_read_b64_tr_b16 v[44:45], v18 offset:0
    ds_read_b64_tr_b16 v[46:47], v19 offset:0
    v_mov_b32 v48, v116
    v_mov_b32 v49, v117
    s_waitcnt lgkmcnt(0)
    s_add_u32 s20, s14, 393216
    s_add_u32 m0, s15, 0
    s_nop 0
    buffer_load_dwordx4 v6, s[48:51], s20 offen offset:0 nt lds
    buffer_load_dwordx4 v7, s[48:51], s20 offen offset:1024 nt lds
    buffer_load_dwordx4 v6, s[48:51], s20 offen offset:2048 nt lds
    buffer_load_dwordx4 v7, s[48:51], s20 offen offset:3072 nt lds
    v_mfma_f32_16x16x16_bf16 v[56:59], v[48:49], v[32:33], v[56:59]
    v_mfma_f32_16x16x16_bf16 v[60:63], v[48:49], v[34:35], v[60:63]
    v_mfma_f32_16x16x16_bf16 v[64:67], v[48:49], v[36:37], v[64:67]
    v_mfma_f32_16x16x16_bf16 v[68:71], v[48:49], v[38:39], v[68:71]
    v_mfma_f32_16x16x16_bf16 v[72:75], v[48:49], v[40:41], v[72:75]
    v_mfma_f32_16x16x16_bf16 v[76:79], v[48:49], v[42:43], v[76:79]
    v_mfma_f32_16x16x16_bf16 v[80:83], v[48:49], v[44:45], v[80:83]
    v_mfma_f32_16x16x16_bf16 v[84:87], v[48:49], v[46:47], v[84:87]
    s_waitcnt vmcnt(12)
    ds_read_b64_tr_b16 v[32:33], v12 offset:4096
    ds_read_b64_tr_b16 v[34:35], v13 offset:4096
    ds_read_b64_tr_b16 v[36:37], v14 offset:4096
    ds_read_b64_tr_b16 v[38:39], v15 offset:4096
    ds_read_b64_tr_b16 v[40:41], v16 offset:4096
    ds_read_b64_tr_b16 v[42:43], v17 offset:4096
    ds_read_b64_tr_b16 v[44:45], v18 offset:4096
    ds_read_b64_tr_b16 v[46:47], v19 offset:4096
    v_mov_b32_dpp v50, v116 row_shl:4 row_mask:0xf bank_mask:0xf
    v_mov_b32_dpp v51, v117 row_shl:4 row_mask:0xf bank_mask:0xf
    s_waitcnt lgkmcnt(0)
    s_add_u32 s20, s14, 425984
    s_add_u32 m0, s15, 4096
    s_nop 0
    buffer_load_dwordx4 v6, s[48:51], s20 offen offset:0 nt lds
    buffer_load_dwordx4 v7, s[48:51], s20 offen offset:1024 nt lds
    buffer_load_dwordx4 v6, s[48:51], s20 offen offset:2048 nt lds
    buffer_load_dwordx4 v7, s[48:51], s20 offen offset:3072 nt lds
    v_mfma_f32_16x16x16_bf16 v[56:59], v[50:51], v[32:33], v[56:59]
    v_mfma_f32_16x16x16_bf16 v[60:63], v[50:51], v[34:35], v[60:63]
    v_mfma_f32_16x16x16_bf16 v[64:67], v[50:51], v[36:37], v[64:67]
    v_mfma_f32_16x16x16_bf16 v[68:71], v[50:51], v[38:39], v[68:71]
    v_mfma_f32_16x16x16_bf16 v[72:75], v[50:51], v[40:41], v[72:75]
    v_mfma_f32_16x16x16_bf16 v[76:79], v[50:51], v[42:43], v[76:79]
    v_mfma_f32_16x16x16_bf16 v[80:83], v[50:51], v[44:45], v[80:83]
    v_mfma_f32_16x16x16_bf16 v[84:87], v[50:51], v[46:47], v[84:87]
    s_waitcnt vmcnt(12)
    ds_read_b64_tr_b16 v[32:33], v12 offset:8192
    ds_read_b64_tr_b16 v[34:35], v13 offset:8192
    ds_read_b64_tr_b16 v[36:37], v14 offset:8192
    ds_read_b64_tr_b16 v[38:39], v15 offset:8192
    ds_read_b64_tr_b16 v[40:41], v16 offset:8192
    ds_read_b64_tr_b16 v[42:43], v17 offset:8192
    ds_read_b64_tr_b16 v[44:45], v18 offset:8192
    ds_read_b64_tr_b16 v[46:47], v19 offset:8192
    v_mov_b32_dpp v48, v116 row_shl:8 row_mask:0xf bank_mask:0xf
    v_mov_b32_dpp v49, v117 row_shl:8 row_mask:0xf bank_mask:0xf
    s_waitcnt lgkmcnt(0)
    s_add_u32 s20, s14, 458752
    s_add_u32 m0, s15, 8192
    s_nop 0
    buffer_load_dwordx4 v6, s[48:51], s20 offen offset:0 nt lds
    buffer_load_dwordx4 v7, s[48:51], s20 offen offset:1024 nt lds
    buffer_load_dwordx4 v6, s[48:51], s20 offen offset:2048 nt lds
    buffer_load_dwordx4 v7, s[48:51], s20 offen offset:3072 nt lds
    v_mfma_f32_16x16x16_bf16 v[56:59], v[48:49], v[32:33], v[56:59]
    v_mfma_f32_16x16x16_bf16 v[60:63], v[48:49], v[34:35], v[60:63]
    v_mfma_f32_16x16x16_bf16 v[64:67], v[48:49], v[36:37], v[64:67]
    v_mfma_f32_16x16x16_bf16 v[68:71], v[48:49], v[38:39], v[68:71]
    v_mfma_f32_16x16x16_bf16 v[72:75], v[48:49], v[40:41], v[72:75]
    v_mfma_f32_16x16x16_bf16 v[76:79], v[48:49], v[42:43], v[76:79]
    v_mfma_f32_16x16x16_bf16 v[80:83], v[48:49], v[44:45], v[80:83]
    v_mfma_f32_16x16x16_bf16 v[84:87], v[48:49], v[46:47], v[84:87]
    s_waitcnt vmcnt(12)
    ds_read_b64_tr_b16 v[32:33], v12 offset:12288
    ds_read_b64_tr_b16 v[34:35], v13 offset:12288
    ds_read_b64_tr_b16 v[36:37], v14 offset:12288
    ds_read_b64_tr_b16 v[38:39], v15 offset:12288
    ds_read_b64_tr_b16 v[40:41], v16 offset:12288
    ds_read_b64_tr_b16 v[42:43], v17 offset:12288
    ds_read_b64_tr_b16 v[44:45], v18 offset:12288
    ds_read_b64_tr_b16 v[46:47], v19 offset:12288
    v_mov_b32_dpp v50, v116 row_shl:12 row_mask:0xf bank_mask:0xf
    v_mov_b32_dpp v51, v117 row_shl:12 row_mask:0xf bank_mask:0xf
    s_waitcnt lgkmcnt(0)
    s_add_u32 s20, s14, 491520
    s_add_u32 m0, s15, 12288
    s_nop 0
    buffer_load_dwordx4 v6, s[48:51], s20 offen offset:0 nt lds
    buffer_load_dwordx4 v7, s[48:51], s20 offen offset:1024 nt lds
    buffer_load_dwordx4 v6, s[48:51], s20 offen offset:2048 nt lds
    buffer_load_dwordx4 v7, s[48:51], s20 offen offset:3072 nt lds
    v_mfma_f32_16x16x16_bf16 v[56:59], v[50:51], v[32:33], v[56:59]
    v_mfma_f32_16x16x16_bf16 v[60:63], v[50:51], v[34:35], v[60:63]
    v_mfma_f32_16x16x16_bf16 v[64:67], v[50:51], v[36:37], v[64:67]
    v_mfma_f32_16x16x16_bf16 v[68:71], v[50:51], v[38:39], v[68:71]
    v_mfma_f32_16x16x16_bf16 v[72:75], v[50:51], v[40:41], v[72:75]
    v_mfma_f32_16x16x16_bf16 v[76:79], v[50:51], v[42:43], v[76:79]
    v_mfma_f32_16x16x16_bf16 v[80:83], v[50:51], v[44:45], v[80:83]
    v_mfma_f32_16x16x16_bf16 v[84:87], v[50:51], v[46:47], v[84:87]
    s_waitcnt vmcnt(12)
    ds_read_b64_tr_b16 v[32:33], v12 offset:0
    ds_read_b64_tr_b16 v[34:35], v13 offset:0
    ds_read_b64_tr_b16 v[36:37], v14 offset:0
    ds_read_b64_tr_b16 v[38:39], v15 offset:0
    ds_read_b64_tr_b16 v[40:41], v16 offset:0
    ds_read_b64_tr_b16 v[42:43], v17 offset:0
    ds_read_b64_tr_b16 v[44:45], v18 offset:0
    ds_read_b64_tr_b16 v[46:47], v19 offset:0
    v_mov_b32 v48, v118
    v_mov_b32 v49, v119
    s_waitcnt lgkmcnt(0)
    s_nop 1
    v_mfma_f32_16x16x16_bf16 v[56:59], v[48:49], v[32:33], v[56:59]
    v_mfma_f32_16x16x16_bf16 v[60:63], v[48:49], v[34:35], v[60:63]
    v_mfma_f32_16x16x16_bf16 v[64:67], v[48:49], v[36:37], v[64:67]
    v_mfma_f32_16x16x16_bf16 v[68:71], v[48:49], v[38:39], v[68:71]
    v_mfma_f32_16x16x16_bf16 v[72:75], v[48:49], v[40:41], v[72:75]
    v_mfma_f32_16x16x16_bf16 v[76:79], v[48:49], v[42:43], v[76:79]
    v_mfma_f32_16x16x16_bf16 v[80:83], v[48:49], v[44:45], v[80:83]
    v_mfma_f32_16x16x16_bf16 v[84:87], v[48:49], v[46:47], v[84:87]
    s_waitcnt vmcnt(8)
    ds_read_b64_tr_b16 v[32:33], v12 offset:4096
    ds_read_b64_tr_b16 v[34:35], v13 offset:4096
    ds_read_b64_tr_b16 v[36:37], v14 offset:4096
    ds_read_b64_tr_b16 v[38:39], v15 offset:4096
    ds_read_b64_tr_b16 v[40:41], v16 offset:4096
    ds_read_b64_tr_b16 v[42:43], v17 offset:4096
    ds_read_b64_tr_b16 v[44:45], v18 offset:4096
    ds_read_b64_tr_b16 v[46:47], v19 offset:4096
    v_mov_b32_dpp v50, v118 row_shl:4 row_mask:0xf bank_mask:0xf
    v_mov_b32_dpp v51, v119 row_shl:4 row_mask:0xf bank_mask:0xf
    s_waitcnt lgkmcnt(0)
    s_nop 1
    v_mfma_f32_16x16x16_bf16 v[56:59], v[50:51], v[32:33], v[56:59]
    v_mfma_f32_16x16x16_bf16 v[60:63], v[50:51], v[34:35], v[60:63]
    v_mfma_f32_16x16x16_bf16 v[64:67], v[50:51], v[36:37], v[64:67]
    v_mfma_f32_16x16x16_bf16 v[68:71], v[50:51], v[38:39], v[68:71]
    v_mfma_f32_16x16x16_bf16 v[72:75], v[50:51], v[40:41], v[72:75]
    v_mfma_f32_16x16x16_bf16 v[76:79], v[50:51], v[42:43], v[76:79]
    v_mfma_f32_16x16x16_bf16 v[80:83], v[50:51], v[44:45], v[80:83]
    v_mfma_f32_16x16x16_bf16 v[84:87], v[50:51], v[46:47], v[84:87]
    s_waitcnt vmcnt(4)
    ds_read_b64_tr_b16 v[32:33], v12 offset:8192
    ds_read_b64_tr_b16 v[34:35], v13 offset:8192
    ds_read_b64_tr_b16 v[36:37], v14 offset:8192
    ds_read_b64_tr_b16 v[38:39], v15 offset:8192
    ds_read_b64_tr_b16 v[40:41], v16 offset:8192
    ds_read_b64_tr_b16 v[42:43], v17 offset:8192
    ds_read_b64_tr_b16 v[44:45], v18 offset:8192
    ds_read_b64_tr_b16 v[46:47], v19 offset:8192
    v_mov_b32_dpp v48, v118 row_shl:8 row_mask:0xf bank_mask:0xf
    v_mov_b32_dpp v49, v119 row_shl:8 row_mask:0xf bank_mask:0xf
    s_waitcnt lgkmcnt(0)
    s_nop 1
    v_mfma_f32_16x16x16_bf16 v[56:59], v[48:49], v[32:33], v[56:59]
    v_mfma_f32_16x16x16_bf16 v[60:63], v[48:49], v[34:35], v[60:63]
    v_mfma_f32_16x16x16_bf16 v[64:67], v[48:49], v[36:37], v[64:67]
    v_mfma_f32_16x16x16_bf16 v[68:71], v[48:49], v[38:39], v[68:71]
    v_mfma_f32_16x16x16_bf16 v[72:75], v[48:49], v[40:41], v[72:75]
    v_mfma_f32_16x16x16_bf16 v[76:79], v[48:49], v[42:43], v[76:79]
    v_mfma_f32_16x16x16_bf16 v[80:83], v[48:49], v[44:45], v[80:83]
    v_mfma_f32_16x16x16_bf16 v[84:87], v[48:49], v[46:47], v[84:87]
    s_waitcnt vmcnt(0)
    ds_read_b64_tr_b16 v[32:33], v12 offset:12288
    ds_read_b64_tr_b16 v[34:35], v13 offset:12288
    ds_read_b64_tr_b16 v[36:37], v14 offset:12288
    ds_read_b64_tr_b16 v[38:39], v15 offset:12288
    ds_read_b64_tr_b16 v[40:41], v16 offset:12288
    ds_read_b64_tr_b16 v[42:43], v17 offset:12288
    ds_read_b64_tr_b16 v[44:45], v18 offset:12288
    ds_read_b64_tr_b16 v[46:47], v19 offset:12288
    v_mov_b32_dpp v50, v118 row_shl:12 row_mask:0xf bank_mask:0xf
    v_mov_b32_dpp v51, v119 row_shl:12 row_mask:0xf bank_mask:0xf
    s_waitcnt lgkmcnt(0)
    s_nop 1
    v_mfma_f32_16x16x16_bf16 v[56:59], v[50:51], v[32:33], v[56:59]
    v_mfma_f32_16x16x16_bf16 v[60:63], v[50:51], v[34:35], v[60:63]
    v_mfma_f32_16x16x16_bf16 v[64:67], v[50:51], v[36:37], v[64:67]
    v_mfma_f32_16x16x16_bf16 v[68:71], v[50:51], v[38:39], v[68:71]
    v_mfma_f32_16x16x16_bf16 v[72:75], v[50:51], v[40:41], v[72:75]
    v_mfma_f32_16x16x16_bf16 v[76:79], v[50:51], v[42:43], v[76:79]
    v_mfma_f32_16x16x16_bf16 v[80:83], v[50:51], v[44:45], v[80:83]
    v_mfma_f32_16x16x16_bf16 v[84:87], v[50:51], v[46:47], v[84:87]
    s_nop 7
    s_nop 1
    v_lshlrev_b32 v28, 2, v0
    v_add_u32 v28, s15, v28
    s_mov_b64 exec, 0xffff
    ds_write_b32 v28, v56 offset:0
    ds_write_b32 v28, v57 offset:512
    ds_write_b32 v28, v58 offset:1024
    ds_write_b32 v28, v59 offset:1536
    ds_write_b32 v28, v60 offset:64
    ds_write_b32 v28, v61 offset:576
    ds_write_b32 v28, v62 offset:1088
    ds_write_b32 v28, v63 offset:1600
    ds_write_b32 v28, v64 offset:128
    ds_write_b32 v28, v65 offset:640
    ds_write_b32 v28, v66 offset:1152
    ds_write_b32 v28, v67 offset:1664
    ds_write_b32 v28, v68 offset:192
    ds_write_b32 v28, v69 offset:704
    ds_write_b32 v28, v70 offset:1216
    ds_write_b32 v28, v71 offset:1728
    ds_write_b32 v28, v72 offset:256
    ds_write_b32 v28, v73 offset:768
    ds_write_b32 v28, v74 offset:1280
    ds_write_b32 v28, v75 offset:1792
    ds_write_b32 v28, v76 offset:320
    ds_write_b32 v28, v77 offset:832
    ds_write_b32 v28, v78 offset:1344
    ds_write_b32 v28, v79 offset:1856
    ds_write_b32 v28, v80 offset:384
    ds_write_b32 v28, v81 offset:896
    ds_write_b32 v28, v82 offset:1408
    ds_write_b32 v28, v83 offset:1920
    ds_write_b32 v28, v84 offset:448
    ds_write_b32 v28, v85 offset:960
    ds_write_b32 v28, v86 offset:1472
    ds_write_b32 v28, v87 offset:1984
    s_mov_b64 exec, 0xf
    v_lshlrev_b32 v28, 3, v0
    v_add_u32 v28, s15, v28
    ds_write_b64 v28, v[52:53] offset:2048
    s_mov_b64 exec, -1
    s_waitcnt lgkmcnt(0)
    s_barrier
    s_endpgm
L_service:
    v_lshrrev_b32 v24, 3, v0
    v_and_b32 v25, 7, v0
    v_mov_b32 v1, 0
    s_cmp_lg_u32 s2, 0
    s_cbranch_scc1 L_nonce_wait
    s_memrealtime s[94:95]
    s_waitcnt lgkmcnt(0)
    s_or_b32 s94, s94, 1
    v_mov_b32 v2, s94
    v_mov_b32 v3, s95
    s_mov_b64 exec, 1
    buffer_store_dwordx2 v[2:3], v1, s[72:75], 0 offen sc1
    s_mov_b64 exec, -1
L_nonce_wait:
    v_lshlrev_b32 v7, 10, v24
    v_lshl_add_u32 v7, v25, 4, v7
    s_mul_i32 s16, s6, 57344
    s_lshl_b32 s17, s7, 7
    s_add_u32 s16, s16, s17
    s_add_u32 s17, s16, 0
    buffer_load_dwordx4 v[128:131], v7, s[64:67], s17 offen
    s_add_u32 s17, s16, 8192
    buffer_load_dwordx4 v[132:135], v7, s[64:67], s17 offen
    s_add_u32 s17, s16, 16384
    buffer_load_dwordx4 v[136:139], v7, s[64:67], s17 offen
    s_add_u32 s17, s16, 24576
    buffer_load_dwordx4 v[140:143], v7, s[64:67], s17 offen
    s_add_u32 s17, s16, 32768
    buffer_load_dwordx4 v[144:147], v7, s[64:67], s17 offen
    s_add_u32 s17, s16, 40960
    buffer_load_dwordx4 v[148:151], v7, s[64:67], s17 offen
    s_add_u32 s17, s16, 49152
    buffer_load_dwordx4 v[152:155], v7, s[64:67], s17 offen
    s_lshl_b32 s16, s6, 17
    s_lshl_b32 s17, s7, 7
    s_add_u32 s16, s16, s17
    s_add_u32 s17, s16, 0
    buffer_load_dwordx4 v[64:67], v7, s[56:59], s17 offen
    s_add_u32 s17, s16, 8192
    buffer_load_dwordx4 v[68:71], v7, s[56:59], s17 offen
    s_add_u32 s17, s16, 16384
    buffer_load_dwordx4 v[72:75], v7, s[56:59], s17 offen
    s_add_u32 s17, s16, 24576
    buffer_load_dwordx4 v[76:79], v7, s[56:59], s17 offen
    s_add_u32 s17, s16, 32768
    buffer_load_dwordx4 v[80:83], v7, s[56:59], s17 offen
    s_add_u32 s17, s16, 40960
    buffer_load_dwordx4 v[84:87], v7, s[56:59], s17 offen
    s_add_u32 s17, s16, 49152
    buffer_load_dwordx4 v[88:91], v7, s[56:59], s17 offen
    s_add_u32 s17, s16, 57344
    buffer_load_dwordx4 v[92:95], v7, s[56:59], s17 offen
    s_add_u32 s17, s16, 65536
    buffer_load_dwordx4 v[96:99], v7, s[56:59], s17 offen
    s_add_u32 s17, s16, 73728
    buffer_load_dwordx4 v[100:103], v7, s[56:59], s17 offen
    s_add_u32 s17, s16, 81920
    buffer_load_dwordx4 v[104:107], v7, s[56:59], s17 offen
    s_add_u32 s17, s16, 90112
    buffer_load_dwordx4 v[108:111], v7, s[56:59], s17 offen
    s_add_u32 s17, s16, 98304
    buffer_load_dwordx4 v[112:115], v7, s[56:59], s17 offen
    s_add_u32 s17, s16, 106496
    buffer_load_dwordx4 v[116:119], v7, s[56:59], s17 offen
    s_add_u32 s17, s16, 114688
    buffer_load_dwordx4 v[120:123], v7, s[56:59], s17 offen
    s_add_u32 s17, s16, 122880
    buffer_load_dwordx4 v[124:127], v7, s[56:59], s17 offen
    s_barrier
    v_lshlrev_b32 v6, 2, v0
    ds_read_b32 v32, v6 offset:2048
    ds_read_b32 v33, v6 offset:2304
    ds_read_b32 v34, v6 offset:2560
    ds_read_b32 v35, v6 offset:2816
    ds_read_b32 v36, v6 offset:3072
    ds_read_b32 v37, v6 offset:3328
    ds_read_b32 v38, v6 offset:3584
    ds_read_b32 v39, v6 offset:3840
    ds_read_b32 v40, v6 offset:4096
    ds_read_b32 v41, v6 offset:4352
    ds_read_b32 v42, v6 offset:4608
    ds_read_b32 v43, v6 offset:4864
    ds_read_b32 v44, v6 offset:5120
    ds_read_b32 v45, v6 offset:5376
    ds_read_b32 v46, v6 offset:5632
    ds_read_b32 v47, v6 offset:5888
    ds_read_b32 v48, v6 offset:6144
    ds_read_b32 v49, v6 offset:6400
    ds_read_b32 v50, v6 offset:6656
    ds_read_b32 v51, v6 offset:6912
    ds_read_b32 v52, v6 offset:7168
    ds_read_b32 v53, v6 offset:7424
    ds_read_b32 v54, v6 offset:7680
    ds_read_b32 v55, v6 offset:7936
    ds_read_b32 v56, v6 offset:8192
    ds_read_b32 v57, v6 offset:8448
    ds_read_b32 v58, v6 offset:8704
    ds_read_b32 v59, v6 offset:8960
    ds_read_b32 v60, v6 offset:9216
    ds_read_b32 v61, v6 offset:9472
    ds_read_b32 v62, v6 offset:9728
    ds_read_b32 v63, v6 offset:9984
    s_waitcnt lgkmcnt(0)
    v_add_f32 v32, v32, v48
    v_add_f32 v33, v33, v49
    v_add_f32 v34, v34, v50
    v_add_f32 v35, v35, v51
    v_add_f32 v36, v36, v52
    v_add_f32 v37, v37, v53
    v_add_f32 v38, v38, v54
    v_add_f32 v39, v39, v55
    v_add_f32 v40, v40, v56
    v_add_f32 v41, v41, v57
    v_add_f32 v42, v42, v58
    v_add_f32 v43, v43, v59
    v_add_f32 v44, v44, v60
    v_add_f32 v45, v45, v61
    v_add_f32 v46, v46, v62
    v_add_f32 v47, v47, v63
    v_add_f32 v32, v32, v40
    v_add_f32 v33, v33, v41
    v_add_f32 v34, v34, v42
    v_add_f32 v35, v35, v43
    v_add_f32 v36, v36, v44
    v_add_f32 v37, v37, v45
    v_add_f32 v38, v38, v46
    v_add_f32 v39, v39, v47
    v_add_f32 v32, v32, v36
    v_add_f32 v33, v33, v37
    v_add_f32 v34, v34, v38
    v_add_f32 v35, v35, v39
    v_add_f32 v32, v32, v34
    v_add_f32 v33, v33, v35
    v_add_f32 v32, v32, v33
    v_mov_b32 v28, v32
    ds_read_b32 v32, v6 offset:10240
    ds_read_b32 v33, v6 offset:10496
    ds_read_b32 v34, v6 offset:10752
    ds_read_b32 v35, v6 offset:11008
    ds_read_b32 v36, v6 offset:11264
    ds_read_b32 v37, v6 offset:11520
    ds_read_b32 v38, v6 offset:11776
    ds_read_b32 v39, v6 offset:12032
    ds_read_b32 v40, v6 offset:12288
    ds_read_b32 v41, v6 offset:12544
    ds_read_b32 v42, v6 offset:12800
    ds_read_b32 v43, v6 offset:13056
    ds_read_b32 v44, v6 offset:13312
    ds_read_b32 v45, v6 offset:13568
    ds_read_b32 v46, v6 offset:13824
    ds_read_b32 v47, v6 offset:14080
    ds_read_b32 v48, v6 offset:14336
    ds_read_b32 v49, v6 offset:14592
    ds_read_b32 v50, v6 offset:14848
    ds_read_b32 v51, v6 offset:15104
    ds_read_b32 v52, v6 offset:15360
    ds_read_b32 v53, v6 offset:15616
    ds_read_b32 v54, v6 offset:15872
    ds_read_b32 v55, v6 offset:16128
    ds_read_b32 v56, v6 offset:16384
    ds_read_b32 v57, v6 offset:16640
    ds_read_b32 v58, v6 offset:16896
    ds_read_b32 v59, v6 offset:17152
    ds_read_b32 v60, v6 offset:17408
    ds_read_b32 v61, v6 offset:17664
    ds_read_b32 v62, v6 offset:17920
    ds_read_b32 v63, v6 offset:18176
    s_waitcnt lgkmcnt(0)
    v_add_f32 v32, v32, v48
    v_add_f32 v33, v33, v49
    v_add_f32 v34, v34, v50
    v_add_f32 v35, v35, v51
    v_add_f32 v36, v36, v52
    v_add_f32 v37, v37, v53
    v_add_f32 v38, v38, v54
    v_add_f32 v39, v39, v55
    v_add_f32 v40, v40, v56
    v_add_f32 v41, v41, v57
    v_add_f32 v42, v42, v58
    v_add_f32 v43, v43, v59
    v_add_f32 v44, v44, v60
    v_add_f32 v45, v45, v61
    v_add_f32 v46, v46, v62
    v_add_f32 v47, v47, v63
    v_add_f32 v32, v32, v40
    v_add_f32 v33, v33, v41
    v_add_f32 v34, v34, v42
    v_add_f32 v35, v35, v43
    v_add_f32 v36, v36, v44
    v_add_f32 v37, v37, v45
    v_add_f32 v38, v38, v46
    v_add_f32 v39, v39, v47
    v_add_f32 v32, v32, v36
    v_add_f32 v33, v33, v37
    v_add_f32 v34, v34, v38
    v_add_f32 v35, v35, v39
    v_add_f32 v32, v32, v34
    v_add_f32 v33, v33, v35
    v_add_f32 v32, v32, v33
    v_mov_b32 v29, v32
    s_lshr_b32 s16, s5, 3
    s_lshl_b32 s16, s16, 14
    s_lshl_b32 s17, s4, 11
    s_add_u32 s16, s16, s17
    s_and_b32 s17, s5, 7
    s_lshl_b32 s17, s17, 8
    s_add_u32 s16, s16, s17
    s_add_u32 s16, s16, 0
    buffer_store_dword v28, v6, s[76:79], s16 offen sc1
    s_mul_i32 s16, s9, 28672
    s_mul_i32 s17, s11, 7168
    s_add_u32 s16, s16, s17
    s_lshl_b32 s17, s12, 8
    s_add_u32 s16, s16, s17
    s_add_u32 s16, s16, 65536
    buffer_store_dword v29, v6, s[76:79], s16 offen sc1
    v_mov_b32 v1, 0
    s_mov_b32 s16, 0
L_nonce_loop:
    buffer_load_dwordx2 v[2:3], v1, s[72:75], 0 offen sc1
    s_waitcnt vmcnt(0)
    v_readfirstlane_b32 s94, v2
    v_readfirstlane_b32 s95, v3
    s_nop 3
    s_and_b32 s17, s94, 1
    s_cmp_lg_u32 s17, 0
    s_cbranch_scc1 L_nonce_done
    s_add_u32 s16, s16, 1
    s_cmp_ge_u32 s16, 0x40000
    s_cbranch_scc1 L_nonce_done
    s_sleep 4
    s_branch L_nonce_loop
L_nonce_done:
    s_mov_b32 s17, s2
    s_waitcnt vmcnt(0)
    v_mov_b32 v2, s94
    v_mov_b32 v3, s95
    s_lshl_b32 s17, s17, 3
    s_add_u32 s17, s17, 1572864
    v_mov_b32 v1, s17
    s_mov_b64 exec, 1
    buffer_store_dwordx2 v[2:3], v1, s[76:79], 0 offen sc1
    s_mov_b64 exec, -1
    v_and_b32 v8, 31, v0
    s_lshl_b32 s16, s4, 5
    v_add_u32 v8, s16, v8
    v_lshlrev_b32 v8, 3, v8
    v_add_u32 v8, 1572864, v8
    s_mov_b32 s16, 0
L_poll_q:
    buffer_load_dwordx2 v[10:11], v8, s[76:79], 0 offen sc1
    s_waitcnt vmcnt(0)
    v_cmp_ne_u64 vcc, s[94:95], v[10:11]
    s_nop 1
    s_cbranch_vccz L_poll_q_done
    s_add_u32 s16, s16, 1
    s_cmp_ge_u32 s16, 0x40000
    s_cbranch_scc1 L_poll_q_done
    s_sleep 2
    s_branch L_poll_q
L_poll_q_done:
    v_lshlrev_b32 v6, 5, v0
    s_lshl_b32 s16, s4, 11
    s_add_u32 s16, s16, 0
    s_add_u32 s17, s16, 0
    buffer_load_dwordx4 v[32:35], v6, s[76:79], s17 offen sc1
    buffer_load_dwordx4 v[36:39], v6, s[76:79], s17 offen offset:16 sc1
    s_add_u32 s17, s16, 16384
    buffer_load_dwordx4 v[40:43], v6, s[76:79], s17 offen sc1
    buffer_load_dwordx4 v[44:47], v6, s[76:79], s17 offen offset:16 sc1
    s_add_u32 s17, s16, 32768
    buffer_load_dwordx4 v[48:51], v6, s[76:79], s17 offen sc1
    buffer_load_dwordx4 v[52:55], v6, s[76:79], s17 offen offset:16 sc1
    s_add_u32 s17, s16, 49152
    buffer_load_dwordx4 v[56:59], v6, s[76:79], s17 offen sc1
    buffer_load_dwordx4 v[60:63], v6, s[76:79], s17 offen offset:16 sc1
    s_waitcnt vmcnt(0)
    v_add_f32 v32, v32, v40
    v_add_f32 v33, v33, v41
    v_add_f32 v34, v34, v42
    v_add_f32 v35, v35, v43
    v_add_f32 v36, v36, v44
    v_add_f32 v37, v37, v45
    v_add_f32 v38, v38, v46
    v_add_f32 v39, v39, v47
    v_add_f32 v32, v32, v48
    v_add_f32 v33, v33, v49
    v_add_f32 v34, v34, v50
    v_add_f32 v35, v35, v51
    v_add_f32 v36, v36, v52
    v_add_f32 v37, v37, v53
    v_add_f32 v38, v38, v54
    v_add_f32 v39, v39, v55
    v_add_f32 v32, v32, v56
    v_add_f32 v33, v33, v57
    v_add_f32 v34, v34, v58
    v_add_f32 v35, v35, v59
    v_add_f32 v36, v36, v60
    v_add_f32 v37, v37, v61
    v_add_f32 v38, v38, v62
    v_add_f32 v39, v39, v63
    v_cvt_pk_bf16_f32 v40, v32, v33
    v_cvt_pk_bf16_f32 v41, v34, v35
    v_cvt_pk_bf16_f32 v42, v36, v37
    v_cvt_pk_bf16_f32 v43, v38, v39
    v_lshlrev_b32 v6, 4, v0
    ds_write_b128 v6, v[40:43] offset:18432
    s_waitcnt lgkmcnt(0)
    s_barrier
    v_lshlrev_b32 v8, 3, v0
    v_add_u32 v8, 1572864, v8
    s_mov_b32 s16, 0
L_poll_b:
    buffer_load_dwordx2 v[10:11], v8, s[76:79], 0 offen offset:0 sc1
    buffer_load_dwordx2 v[12:13], v8, s[76:79], 0 offen offset:512 sc1
    buffer_load_dwordx2 v[14:15], v8, s[76:79], 0 offen offset:1024 sc1
    buffer_load_dwordx2 v[16:17], v8, s[76:79], 0 offen offset:1536 sc1
    s_waitcnt vmcnt(0)
    v_cmp_ne_u64 vcc, s[94:95], v[10:11]
    v_cmp_ne_u64 s[18:19], s[94:95], v[12:13]
    s_nop 1
    s_or_b64 vcc, vcc, s[18:19]
    v_cmp_ne_u64 s[18:19], s[94:95], v[14:15]
    s_nop 1
    s_or_b64 vcc, vcc, s[18:19]
    v_cmp_ne_u64 s[18:19], s[94:95], v[16:17]
    s_nop 1
    s_or_b64 vcc, vcc, s[18:19]
    s_cbranch_vccz L_poll_b_done
    s_add_u32 s16, s16, 1
    s_cmp_ge_u32 s16, 0x40000
    s_cbranch_scc1 L_poll_b_done
    s_sleep 2
    s_branch L_poll_b
L_poll_b_done:
    v_min_u32 v6, 55, v0
    s_mul_i32 s16, s6, 56
    v_add_u32 v6, s16, v6
    v_lshlrev_b32 v6, 2, v6
    s_mov_b32 s17, 65536
    buffer_load_dword v32, v6, s[76:79], s17 offen sc1
    s_mov_b32 s17, 72704
    buffer_load_dword v33, v6, s[76:79], s17 offen sc1
    s_mov_b32 s17, 79872
    buffer_load_dword v34, v6, s[76:79], s17 offen sc1
    s_mov_b32 s17, 87040
    buffer_load_dword v35, v6, s[76:79], s17 offen sc1
    s_mov_b32 s17, 94208
    buffer_load_dword v36, v6, s[76:79], s17 offen sc1
    s_mov_b32 s17, 101376
    buffer_load_dword v37, v6, s[76:79], s17 offen sc1
    s_mov_b32 s17, 108544
    buffer_load_dword v38, v6, s[76:79], s17 offen sc1
    s_mov_b32 s17, 115712
    buffer_load_dword v39, v6, s[76:79], s17 offen sc1
    s_waitcnt vmcnt(0)
    v_add_f32 v32, v32, v33
    v_add_f32 v32, v32, v34
    v_add_f32 v32, v32, v35
    v_add_f32 v36, v36, v37
    v_add_f32 v36, v36, v38
    v_add_f32 v36, v36, v39
    v_cvt_pk_bf16_f32 v4, v32, v36
    v_lshlrev_b32 v32, 16, v4
    v_and_b32 v36, 0xffff0000, v4
    v_mul_f32 v33, 0xbfb8aa3b, v32
    v_exp_f32 v33, v33
    s_nop 0
    v_add_f32 v33, 1.0, v33
    v_rcp_f32 v34, v33
    s_nop 0
    v_mul_f32 v35, v32, v34
    v_cvt_pk_bf16_f32 v4, v35, v35
    v_lshlrev_b32 v35, 16, v4
    v_mul_f32 v35, v35, v36
    v_cvt_pk_bf16_f32 v4, v35, v35
    v_lshlrev_b32 v35, 16, v4
    v_lshlrev_b32 v6, 2, v0
    ds_write_b32 v6, v35 offset:19456
    v_lshlrev_b32 v6, 2, v24
    s_waitcnt lgkmcnt(0)
    ds_read_b32 v32, v6 offset:19456
    ds_read_b32 v33, v6 offset:19488
    ds_read_b32 v34, v6 offset:19520
    ds_read_b32 v35, v6 offset:19552
    ds_read_b32 v36, v6 offset:19584
    ds_read_b32 v37, v6 offset:19616
    ds_read_b32 v38, v6 offset:19648
    s_waitcnt lgkmcnt(0)
    v_mov_b32 v40, 0
    v_mov_b32 v41, 0
    v_mov_b32 v42, 0
    v_mov_b32 v43, 0
    v_mov_b32 v44, 0
    v_mov_b32 v45, 0
    v_mov_b32 v46, 0
    v_mov_b32 v47, 0
    v_lshlrev_b32 v4, 16, v128
    v_and_b32 v5, 0xffff0000, v128
    v_fmac_f32 v40, v32, v4
    v_fmac_f32 v41, v32, v5
    v_lshlrev_b32 v4, 16, v129
    v_and_b32 v5, 0xffff0000, v129
    v_fmac_f32 v42, v32, v4
    v_fmac_f32 v43, v32, v5
    v_lshlrev_b32 v4, 16, v130
    v_and_b32 v5, 0xffff0000, v130
    v_fmac_f32 v44, v32, v4
    v_fmac_f32 v45, v32, v5
    v_lshlrev_b32 v4, 16, v131
    v_and_b32 v5, 0xffff0000, v131
    v_fmac_f32 v46, v32, v4
    v_fmac_f32 v47, v32, v5
    v_lshlrev_b32 v4, 16, v132
    v_and_b32 v5, 0xffff0000, v132
    v_fmac_f32 v40, v33, v4
    v_fmac_f32 v41, v33, v5
    v_lshlrev_b32 v4, 16, v133
    v_and_b32 v5, 0xffff0000, v133
    v_fmac_f32 v42, v33, v4
    v_fmac_f32 v43, v33, v5
    v_lshlrev_b32 v4, 16, v134
    v_and_b32 v5, 0xffff0000, v134
    v_fmac_f32 v44, v33, v4
    v_fmac_f32 v45, v33, v5
    v_lshlrev_b32 v4, 16, v135
    v_and_b32 v5, 0xffff0000, v135
    v_fmac_f32 v46, v33, v4
    v_fmac_f32 v47, v33, v5
    v_lshlrev_b32 v4, 16, v136
    v_and_b32 v5, 0xffff0000, v136
    v_fmac_f32 v40, v34, v4
    v_fmac_f32 v41, v34, v5
    v_lshlrev_b32 v4, 16, v137
    v_and_b32 v5, 0xffff0000, v137
    v_fmac_f32 v42, v34, v4
    v_fmac_f32 v43, v34, v5
    v_lshlrev_b32 v4, 16, v138
    v_and_b32 v5, 0xffff0000, v138
    v_fmac_f32 v44, v34, v4
    v_fmac_f32 v45, v34, v5
    v_lshlrev_b32 v4, 16, v139
    v_and_b32 v5, 0xffff0000, v139
    v_fmac_f32 v46, v34, v4
    v_fmac_f32 v47, v34, v5
    v_lshlrev_b32 v4, 16, v140
    v_and_b32 v5, 0xffff0000, v140
    v_fmac_f32 v40, v35, v4
    v_fmac_f32 v41, v35, v5
    v_lshlrev_b32 v4, 16, v141
    v_and_b32 v5, 0xffff0000, v141
    v_fmac_f32 v42, v35, v4
    v_fmac_f32 v43, v35, v5
    v_lshlrev_b32 v4, 16, v142
    v_and_b32 v5, 0xffff0000, v142
    v_fmac_f32 v44, v35, v4
    v_fmac_f32 v45, v35, v5
    v_lshlrev_b32 v4, 16, v143
    v_and_b32 v5, 0xffff0000, v143
    v_fmac_f32 v46, v35, v4
    v_fmac_f32 v47, v35, v5
    v_lshlrev_b32 v4, 16, v144
    v_and_b32 v5, 0xffff0000, v144
    v_fmac_f32 v40, v36, v4
    v_fmac_f32 v41, v36, v5
    v_lshlrev_b32 v4, 16, v145
    v_and_b32 v5, 0xffff0000, v145
    v_fmac_f32 v42, v36, v4
    v_fmac_f32 v43, v36, v5
    v_lshlrev_b32 v4, 16, v146
    v_and_b32 v5, 0xffff0000, v146
    v_fmac_f32 v44, v36, v4
    v_fmac_f32 v45, v36, v5
    v_lshlrev_b32 v4, 16, v147
    v_and_b32 v5, 0xffff0000, v147
    v_fmac_f32 v46, v36, v4
    v_fmac_f32 v47, v36, v5
    v_lshlrev_b32 v4, 16, v148
    v_and_b32 v5, 0xffff0000, v148
    v_fmac_f32 v40, v37, v4
    v_fmac_f32 v41, v37, v5
    v_lshlrev_b32 v4, 16, v149
    v_and_b32 v5, 0xffff0000, v149
    v_fmac_f32 v42, v37, v4
    v_fmac_f32 v43, v37, v5
    v_lshlrev_b32 v4, 16, v150
    v_and_b32 v5, 0xffff0000, v150
    v_fmac_f32 v44, v37, v4
    v_fmac_f32 v45, v37, v5
    v_lshlrev_b32 v4, 16, v151
    v_and_b32 v5, 0xffff0000, v151
    v_fmac_f32 v46, v37, v4
    v_fmac_f32 v47, v37, v5
    v_lshlrev_b32 v4, 16, v152
    v_and_b32 v5, 0xffff0000, v152
    v_fmac_f32 v40, v38, v4
    v_fmac_f32 v41, v38, v5
    v_lshlrev_b32 v4, 16, v153
    v_and_b32 v5, 0xffff0000, v153
    v_fmac_f32 v42, v38, v4
    v_fmac_f32 v43, v38, v5
    v_lshlrev_b32 v4, 16, v154
    v_and_b32 v5, 0xffff0000, v154
    v_fmac_f32 v44, v38, v4
    v_fmac_f32 v45, v38, v5
    v_lshlrev_b32 v4, 16, v155
    v_and_b32 v5, 0xffff0000, v155
    v_fmac_f32 v46, v38, v4
    v_fmac_f32 v47, v38, v5
    s_nop 1
    v_add_f32_dpp v40, v40, v40 row_ror:8 row_mask:0xf bank_mask:0xf
    v_mov_b32 v4, v40
    s_nop 1
    v_permlane16_swap_b32 v40, v4
    s_nop 1
    v_add_f32 v40, v40, v4
    v_mov_b32 v4, v40
    s_nop 1
    v_permlane32_swap_b32 v40, v4
    s_nop 1
    v_add_f32 v40, v40, v4
    s_nop 1
    v_add_f32_dpp v41, v41, v41 row_ror:8 row_mask:0xf bank_mask:0xf
    v_mov_b32 v4, v41
    s_nop 1
    v_permlane16_swap_b32 v41, v4
    s_nop 1
    v_add_f32 v41, v41, v4
    v_mov_b32 v4, v41
    s_nop 1
    v_permlane32_swap_b32 v41, v4
    s_nop 1
    v_add_f32 v41, v41, v4
    s_nop 1
    v_add_f32_dpp v42, v42, v42 row_ror:8 row_mask:0xf bank_mask:0xf
    v_mov_b32 v4, v42
    s_nop 1
    v_permlane16_swap_b32 v42, v4
    s_nop 1
    v_add_f32 v42, v42, v4
    v_mov_b32 v4, v42
    s_nop 1
    v_permlane32_swap_b32 v42, v4
    s_nop 1
    v_add_f32 v42, v42, v4
    s_nop 1
    v_add_f32_dpp v43, v43, v43 row_ror:8 row_mask:0xf bank_mask:0xf
    v_mov_b32 v4, v43
    s_nop 1
    v_permlane16_swap_b32 v43, v4
    s_nop 1
    v_add_f32 v43, v43, v4
    v_mov_b32 v4, v43
    s_nop 1
    v_permlane32_swap_b32 v43, v4
    s_nop 1
    v_add_f32 v43, v43, v4
    s_nop 1
    v_add_f32_dpp v44, v44, v44 row_ror:8 row_mask:0xf bank_mask:0xf
    v_mov_b32 v4, v44
    s_nop 1
    v_permlane16_swap_b32 v44, v4
    s_nop 1
    v_add_f32 v44, v44, v4
    v_mov_b32 v4, v44
    s_nop 1
    v_permlane32_swap_b32 v44, v4
    s_nop 1
    v_add_f32 v44, v44, v4
    s_nop 1
    v_add_f32_dpp v45, v45, v45 row_ror:8 row_mask:0xf bank_mask:0xf
    v_mov_b32 v4, v45
    s_nop 1
    v_permlane16_swap_b32 v45, v4
    s_nop 1
    v_add_f32 v45, v45, v4
    v_mov_b32 v4, v45
    s_nop 1
    v_permlane32_swap_b32 v45, v4
    s_nop 1
    v_add_f32 v45, v45, v4
    s_nop 1
    v_add_f32_dpp v46, v46, v46 row_ror:8 row_mask:0xf bank_mask:0xf
    v_mov_b32 v4, v46
    s_nop 1
    v_permlane16_swap_b32 v46, v4
    s_nop 1
    v_add_f32 v46, v46, v4
    v_mov_b32 v4, v46
    s_nop 1
    v_permlane32_swap_b32 v46, v4
    s_nop 1
    v_add_f32 v46, v46, v4
    s_nop 1
    v_add_f32_dpp v47, v47, v47 row_ror:8 row_mask:0xf bank_mask:0xf
    v_mov_b32 v4, v47
    s_nop 1
    v_permlane16_swap_b32 v47, v4
    s_nop 1
    v_add_f32 v47, v47, v4
    v_mov_b32 v4, v47
    s_nop 1
    v_permlane32_swap_b32 v47, v4
    s_nop 1
    v_add_f32 v47, v47, v4
    s_lshl_b32 s16, s7, 13
    s_lshl_b32 s17, s6, 8
    s_add_u32 s16, s16, s17
    s_add_u32 s16, s16, 729088
    v_lshlrev_b32 v6, 5, v0
    s_mov_b64 exec, 0xff
    buffer_store_dwordx4 v[40:43], v6, s[76:79], s16 offen sc1
    buffer_store_dwordx4 v[44:47], v6, s[76:79], s16 offen offset:16 sc1
    s_mov_b64 exec, -1
    s_barrier
    v_and_b32 v6, 31, v0
    v_lshrrev_b32 v8, 2, v6
    v_lshlrev_b32 v8, 14, v8
    v_and_b32 v10, 3, v0
    v_lshl_add_u32 v8, v10, 3, v8
    ds_read_b64 v[12:13], v8 offset:26624
    s_waitcnt lgkmcnt(0)
    v_mov_b32 v14, v12
    s_nop 1
    v_max_f32_dpp v14, v14, v14 row_ror:4 row_mask:0xf bank_mask:0xf
    s_nop 1
    v_max_f32_dpp v14, v14, v14 row_ror:8 row_mask:0xf bank_mask:0xf
    v_mov_b32 v4, v14
    s_nop 1
    v_permlane16_swap_b32 v14, v4
    s_nop 1
    v_max_f32 v14, v14, v4
    v_sub_f32 v15, v12, v14
    v_mul_f32 v15, 0x3fb8aa3b, v15
    v_exp_f32 v15, v15
    s_nop 0
    v_mul_f32 v16, v15, v13
    s_nop 1
    v_add_f32_dpp v16, v16, v16 row_ror:4 row_mask:0xf bank_mask:0xf
    s_nop 1
    v_add_f32_dpp v16, v16, v16 row_ror:8 row_mask:0xf bank_mask:0xf
    v_mov_b32 v4, v16
    s_nop 1
    v_permlane16_swap_b32 v16, v4
    s_nop 1
    v_add_f32 v16, v16, v4
    v_lshlrev_b32 v8, 2, v6
    ds_write_b32 v8, v15 offset:20352
    v_mov_b32 v17, v16
    v_mov_b32 v16, v14
    v_lshrrev_b32 v8, 4, v0
    v_and_b32 v10, 15, v0
    v_lshlrev_b32 v18, 9, v8
    v_lshl_add_u32 v18, v10, 5, v18
    v_add_u32 v18, 24576, v18
    v_add_u32 v11, 0x10000, v18
    v_lshlrev_b32 v19, 2, v8
    s_waitcnt lgkmcnt(0)
    ds_read_b32 v20, v19 offset:20352
    ds_read_b32 v21, v19 offset:20368
    ds_read_b32 v22, v19 offset:20384
    ds_read_b32 v23, v19 offset:20400
    ds_read_b32 v24, v19 offset:20416
    ds_read_b32 v25, v19 offset:20432
    ds_read_b32 v26, v19 offset:20448
    ds_read_b32 v27, v19 offset:20464
    v_mov_b32 v28, 0
    v_mov_b32 v29, 0
    v_mov_b32 v30, 0
    v_mov_b32 v31, 0
    v_mov_b32 v32, 0
    v_mov_b32 v33, 0
    v_mov_b32 v34, 0
    v_mov_b32 v35, 0
    ds_read_b128 v[36:39], v18 offset:0
    ds_read_b128 v[40:43], v18 offset:16
    ds_read_b128 v[44:47], v18 offset:16384
    ds_read_b128 v[48:51], v18 offset:16400
    ds_read_b128 v[52:55], v18 offset:32768
    ds_read_b128 v[56:59], v18 offset:32784
    s_waitcnt lgkmcnt(0)
    v_fmac_f32 v28, v20, v36
    v_fmac_f32 v29, v20, v37
    v_fmac_f32 v30, v20, v38
    v_fmac_f32 v31, v20, v39
    v_fmac_f32 v32, v20, v40
    v_fmac_f32 v33, v20, v41
    v_fmac_f32 v34, v20, v42
    v_fmac_f32 v35, v20, v43
    v_fmac_f32 v28, v21, v44
    v_fmac_f32 v29, v21, v45
    v_fmac_f32 v30, v21, v46
    v_fmac_f32 v31, v21, v47
    v_fmac_f32 v32, v21, v48
    v_fmac_f32 v33, v21, v49
    v_fmac_f32 v34, v21, v50
    v_fmac_f32 v35, v21, v51
    v_fmac_f32 v28, v22, v52
    v_fmac_f32 v29, v22, v53
    v_fmac_f32 v30, v22, v54
    v_fmac_f32 v31, v22, v55
    v_fmac_f32 v32, v22, v56
    v_fmac_f32 v33, v22, v57
    v_fmac_f32 v34, v22, v58
    v_fmac_f32 v35, v22, v59
    ds_read_b128 v[36:39], v18 offset:49152
    ds_read_b128 v[40:43], v18 offset:49168
    ds_read_b128 v[44:47], v11 offset:0
    ds_read_b128 v[48:51], v11 offset:16
    ds_read_b128 v[52:55], v11 offset:16384
    ds_read_b128 v[56:59], v11 offset:16400
    s_waitcnt lgkmcnt(0)
    v_fmac_f32 v28, v23, v36
    v_fmac_f32 v29, v23, v37
    v_fmac_f32 v30, v23, v38
    v_fmac_f32 v31, v23, v39
    v_fmac_f32 v32, v23, v40
    v_fmac_f32 v33, v23, v41
    v_fmac_f32 v34, v23, v42
    v_fmac_f32 v35, v23, v43
    v_fmac_f32 v28, v24, v44
    v_fmac_f32 v29, v24, v45
    v_fmac_f32 v30, v24, v46
    v_fmac_f32 v31, v24, v47
    v_fmac_f32 v32, v24, v48
    v_fmac_f32 v33, v24, v49
    v_fmac_f32 v34, v24, v50
    v_fmac_f32 v35, v24, v51
    v_fmac_f32 v28, v25, v52
    v_fmac_f32 v29, v25, v53
    v_fmac_f32 v30, v25, v54
    v_fmac_f32 v31, v25, v55
    v_fmac_f32 v32, v25, v56
    v_fmac_f32 v33, v25, v57
    v_fmac_f32 v34, v25, v58
    v_fmac_f32 v35, v25, v59
    ds_read_b128 v[36:39], v11 offset:32768
    ds_read_b128 v[40:43], v11 offset:32784
    ds_read_b128 v[44:47], v11 offset:49152
    ds_read_b128 v[48:51], v11 offset:49168
    s_waitcnt lgkmcnt(0)
    v_fmac_f32 v28, v26, v36
    v_fmac_f32 v29, v26, v37
    v_fmac_f32 v30, v26, v38
    v_fmac_f32 v31, v26, v39
    v_fmac_f32 v32, v26, v40
    v_fmac_f32 v33, v26, v41
    v_fmac_f32 v34, v26, v42
    v_fmac_f32 v35, v26, v43
    v_fmac_f32 v28, v27, v44
    v_fmac_f32 v29, v27, v45
    v_fmac_f32 v30, v27, v46
    v_fmac_f32 v31, v27, v47
    v_fmac_f32 v32, v27, v48
    v_fmac_f32 v33, v27, v49
    v_fmac_f32 v34, v27, v50
    v_fmac_f32 v35, v27, v51
    v_lshlrev_b32 v18, 14, v8
    v_lshl_add_u32 v18, v10, 5, v18
    s_lshl_b32 s16, s4, 16
    s_lshl_b32 s17, s5, 9
    s_add_u32 s16, s16, s17
    s_add_u32 s16, s16, 131072
    buffer_store_dwordx4 v[28:31], v18, s[76:79], s16 offen sc1
    buffer_store_dwordx4 v[32:35], v18, s[76:79], s16 offen offset:16 sc1
    v_lshlrev_b32 v18, 8, v0
    s_lshl_b32 s16, s4, 10
    s_lshl_b32 s17, s5, 3
    s_add_u32 s16, s16, s17
    s_add_u32 s16, s16, 655360
    s_mov_b64 exec, 0xf
    buffer_store_dwordx2 v[16:17], v18, s[76:79], s16 offen sc1
    s_mov_b64 exec, -1
    s_mov_b32 s17, s2
    s_waitcnt vmcnt(0)
    v_mov_b32 v2, s94
    v_mov_b32 v3, s95
    s_lshl_b32 s17, s17, 3
    s_add_u32 s17, s17, 1574912
    v_mov_b32 v1, s17
    s_mov_b64 exec, 1
    buffer_store_dwordx2 v[2:3], v1, s[76:79], 0 offen sc1
    s_mov_b64 exec, -1
    v_and_b32 v8, 31, v0
    s_lshl_b32 s16, s4, 5
    v_add_u32 v8, s16, v8
    v_lshlrev_b32 v8, 3, v8
    v_add_u32 v8, 1574912, v8
    s_mov_b32 s16, 0
L_poll_a:
    buffer_load_dwordx2 v[10:11], v8, s[76:79], 0 offen sc1
    s_waitcnt vmcnt(0)
    v_cmp_ne_u64 vcc, s[94:95], v[10:11]
    s_nop 1
    s_cbranch_vccz L_poll_a_done
    s_add_u32 s16, s16, 1
    s_cmp_ge_u32 s16, 0x40000
    s_cbranch_scc1 L_poll_a_done
    s_sleep 2
    s_branch L_poll_a
L_poll_a_done:
    v_and_b32 v6, 31, v0
    v_lshlrev_b32 v8, 3, v6
    s_lshl_b32 s16, s6, 8
    s_add_u32 s16, s16, 655360
    buffer_load_dwordx2 v[12:13], v8, s[76:79], s16 offen sc1
    v_lshrrev_b32 v10, 5, v0
    v_lshlrev_b32 v8, 9, v10
    v_lshl_add_u32 v8, v6, 4, v8
    s_lshl_b32 s16, s6, 14
    s_add_u32 s16, s16, 131072
    s_add_u32 s17, s16, 0
    buffer_load_dwordx4 v[128:131], v8, s[76:79], s17 offen sc1
    s_add_u32 s17, s16, 1024
    buffer_load_dwordx4 v[132:135], v8, s[76:79], s17 offen sc1
    s_add_u32 s17, s16, 2048
    buffer_load_dwordx4 v[136:139], v8, s[76:79], s17 offen sc1
    s_add_u32 s17, s16, 3072
    buffer_load_dwordx4 v[140:143], v8, s[76:79], s17 offen sc1
    s_add_u32 s17, s16, 4096
    buffer_load_dwordx4 v[144:147], v8, s[76:79], s17 offen sc1
    s_add_u32 s17, s16, 5120
    buffer_load_dwordx4 v[148:151], v8, s[76:79], s17 offen sc1
    s_add_u32 s17, s16, 6144
    buffer_load_dwordx4 v[152:155], v8, s[76:79], s17 offen sc1
    s_add_u32 s17, s16, 7168
    buffer_load_dwordx4 v[156:159], v8, s[76:79], s17 offen sc1
    s_add_u32 s17, s16, 8192
    buffer_load_dwordx4 v[160:163], v8, s[76:79], s17 offen sc1
    s_add_u32 s17, s16, 9216
    buffer_load_dwordx4 v[164:167], v8, s[76:79], s17 offen sc1
    s_add_u32 s17, s16, 10240
    buffer_load_dwordx4 v[40:43], v8, s[76:79], s17 offen sc1
    s_add_u32 s17, s16, 11264
    buffer_load_dwordx4 v[44:47], v8, s[76:79], s17 offen sc1
    s_add_u32 s17, s16, 12288
    buffer_load_dwordx4 v[48:51], v8, s[76:79], s17 offen sc1
    s_add_u32 s17, s16, 13312
    buffer_load_dwordx4 v[52:55], v8, s[76:79], s17 offen sc1
    s_add_u32 s17, s16, 14336
    buffer_load_dwordx4 v[56:59], v8, s[76:79], s17 offen sc1
    s_add_u32 s17, s16, 15360
    buffer_load_dwordx4 v[60:63], v8, s[76:79], s17 offen sc1
    s_waitcnt vmcnt(16)
    v_mov_b32 v14, v12
    s_nop 1
    v_max_f32_dpp v14, v14, v14 quad_perm:[1,0,3,2] row_mask:0xf bank_mask:0xf
    s_nop 1
    v_max_f32_dpp v14, v14, v14 quad_perm:[2,3,0,1] row_mask:0xf bank_mask:0xf
    s_nop 1
    v_max_f32_dpp v14, v14, v14 row_ror:4 row_mask:0xf bank_mask:0xf
    s_nop 1
    v_max_f32_dpp v14, v14, v14 row_ror:8 row_mask:0xf bank_mask:0xf
    v_mov_b32 v4, v14
    s_nop 1
    v_permlane16_swap_b32 v14, v4
    s_nop 1
    v_max_f32 v14, v14, v4
    v_sub_f32 v15, v12, v14
    v_mul_f32 v15, 0x3fb8aa3b, v15
    v_exp_f32 v15, v15
    s_nop 0
    v_mul_f32 v16, v15, v13
    s_nop 1
    v_add_f32_dpp v16, v16, v16 quad_perm:[1,0,3,2] row_mask:0xf bank_mask:0xf
    s_nop 1
    v_add_f32_dpp v16, v16, v16 quad_perm:[2,3,0,1] row_mask:0xf bank_mask:0xf
    s_nop 1
    v_add_f32_dpp v16, v16, v16 row_ror:4 row_mask:0xf bank_mask:0xf
    s_nop 1
    v_add_f32_dpp v16, v16, v16 row_ror:8 row_mask:0xf bank_mask:0xf
    v_mov_b32 v4, v16
    s_nop 1
    v_permlane16_swap_b32 v16, v4
    s_nop 1
    v_add_f32 v16, v16, v4
    v_lshlrev_b32 v8, 2, v6
    ds_write_b32 v8, v15 offset:19712
    v_lshlrev_b32 v8, 2, v10
    s_waitcnt lgkmcnt(0)
    ds_read_b32 v20, v8 offset:19712
    ds_read_b32 v21, v8 offset:19720
    ds_read_b32 v22, v8 offset:19728
    ds_read_b32 v23, v8 offset:19736
    ds_read_b32 v24, v8 offset:19744
    ds_read_b32 v25, v8 offset:19752
    ds_read_b32 v26, v8 offset:19760
    ds_read_b32 v27, v8 offset:19768
    ds_read_b32 v28, v8 offset:19776
    ds_read_b32 v29, v8 offset:19784
    ds_read_b32 v30, v8 offset:19792
    ds_read_b32 v31, v8 offset:19800
    ds_read_b32 v32, v8 offset:19808
    ds_read_b32 v33, v8 offset:19816
    ds_read_b32 v34, v8 offset:19824
    ds_read_b32 v35, v8 offset:19832
    v_mov_b32 v36, 0
    v_mov_b32 v37, 0
    v_mov_b32 v38, 0
    v_mov_b32 v39, 0
    s_waitcnt vmcnt(0) lgkmcnt(0)
    v_fmac_f32 v36, v20, v128
    v_fmac_f32 v37, v20, v129
    v_fmac_f32 v38, v20, v130
    v_fmac_f32 v39, v20, v131
    v_fmac_f32 v36, v21, v132
    v_fmac_f32 v37, v21, v133
    v_fmac_f32 v38, v21, v134
    v_fmac_f32 v39, v21, v135
    v_fmac_f32 v36, v22, v136
    v_fmac_f32 v37, v22, v137
    v_fmac_f32 v38, v22, v138
    v_fmac_f32 v39, v22, v139
    v_fmac_f32 v36, v23, v140
    v_fmac_f32 v37, v23, v141
    v_fmac_f32 v38, v23, v142
    v_fmac_f32 v39, v23, v143
    v_fmac_f32 v36, v24, v144
    v_fmac_f32 v37, v24, v145
    v_fmac_f32 v38, v24, v146
    v_fmac_f32 v39, v24, v147
    v_fmac_f32 v36, v25, v148
    v_fmac_f32 v37, v25, v149
    v_fmac_f32 v38, v25, v150
    v_fmac_f32 v39, v25, v151
    v_fmac_f32 v36, v26, v152
    v_fmac_f32 v37, v26, v153
    v_fmac_f32 v38, v26, v154
    v_fmac_f32 v39, v26, v155
    v_fmac_f32 v36, v27, v156
    v_fmac_f32 v37, v27, v157
    v_fmac_f32 v38, v27, v158
    v_fmac_f32 v39, v27, v159
    v_fmac_f32 v36, v28, v160
    v_fmac_f32 v37, v28, v161
    v_fmac_f32 v38, v28, v162
    v_fmac_f32 v39, v28, v163
    v_fmac_f32 v36, v29, v164
    v_fmac_f32 v37, v29, v165
    v_fmac_f32 v38, v29, v166
    v_fmac_f32 v39, v29, v167
    v_fmac_f32 v36, v30, v40
    v_fmac_f32 v37, v30, v41
    v_fmac_f32 v38, v30, v42
    v_fmac_f32 v39, v30, v43
    v_fmac_f32 v36, v31, v44
    v_fmac_f32 v37, v31, v45
    v_fmac_f32 v38, v31, v46
    v_fmac_f32 v39, v31, v47
    v_fmac_f32 v36, v32, v48
    v_fmac_f32 v37, v32, v49
    v_fmac_f32 v38, v32, v50
    v_fmac_f32 v39, v32, v51
    v_fmac_f32 v36, v33, v52
    v_fmac_f32 v37, v33, v53
    v_fmac_f32 v38, v33, v54
    v_fmac_f32 v39, v33, v55
    v_fmac_f32 v36, v34, v56
    v_fmac_f32 v37, v34, v57
    v_fmac_f32 v38, v34, v58
    v_fmac_f32 v39, v34, v59
    v_fmac_f32 v36, v35, v60
    v_fmac_f32 v37, v35, v61
    v_fmac_f32 v38, v35, v62
    v_fmac_f32 v39, v35, v63
    v_mov_b32 v4, v36
    s_nop 1
    v_permlane32_swap_b32 v36, v4
    s_nop 1
    v_add_f32 v36, v36, v4
    v_mov_b32 v4, v37
    s_nop 1
    v_permlane32_swap_b32 v37, v4
    s_nop 1
    v_add_f32 v37, v37, v4
    v_mov_b32 v4, v38
    s_nop 1
    v_permlane32_swap_b32 v38, v4
    s_nop 1
    v_add_f32 v38, v38, v4
    v_mov_b32 v4, v39
    s_nop 1
    v_permlane32_swap_b32 v39, v4
    s_nop 1
    v_add_f32 v39, v39, v4
    v_rcp_f32 v17, v16
    s_nop 0
    v_mul_f32 v18, v36, v17
    v_fma_f32 v19, -v18, v16, v36
    v_fma_f32 v36, v19, v17, v18
    v_mul_f32 v18, v37, v17
    v_fma_f32 v19, -v18, v16, v37
    v_fma_f32 v37, v19, v17, v18
    v_mul_f32 v18, v38, v17
    v_fma_f32 v19, -v18, v16, v38
    v_fma_f32 v38, v19, v17, v18
    v_mul_f32 v18, v39, v17
    v_fma_f32 v19, -v18, v16, v39
    v_fma_f32 v39, v19, v17, v18
    v_cvt_pk_bf16_f32 v4, v36, v37
    v_lshlrev_b32 v36, 16, v4
    v_and_b32 v37, 0xffff0000, v4
    v_cvt_pk_bf16_f32 v4, v38, v39
    v_lshlrev_b32 v38, 16, v4
    v_and_b32 v39, 0xffff0000, v4
    v_lshlrev_b32 v8, 4, v6
    ds_write_b128 v8, v[36:39] offset:19840
    v_lshrrev_b32 v8, 3, v0
    v_lshlrev_b32 v8, 2, v8
    s_waitcnt lgkmcnt(0)
    ds_read_b32 v20, v8 offset:19840
    ds_read_b32 v21, v8 offset:19872
    ds_read_b32 v22, v8 offset:19904
    ds_read_b32 v23, v8 offset:19936
    ds_read_b32 v24, v8 offset:19968
    ds_read_b32 v25, v8 offset:20000
    ds_read_b32 v26, v8 offset:20032
    ds_read_b32 v27, v8 offset:20064
    ds_read_b32 v28, v8 offset:20096
    ds_read_b32 v29, v8 offset:20128
    ds_read_b32 v30, v8 offset:20160
    ds_read_b32 v31, v8 offset:20192
    ds_read_b32 v32, v8 offset:20224
    ds_read_b32 v33, v8 offset:20256
    ds_read_b32 v34, v8 offset:20288
    ds_read_b32 v35, v8 offset:20320
    s_waitcnt lgkmcnt(0)
    v_mov_b32 v48, 0
    v_mov_b32 v49, 0
    v_mov_b32 v50, 0
    v_mov_b32 v51, 0
    v_mov_b32 v52, 0
    v_mov_b32 v53, 0
    v_mov_b32 v54, 0
    v_mov_b32 v55, 0
    v_lshlrev_b32 v4, 16, v64
    v_and_b32 v5, 0xffff0000, v64
    v_fmac_f32 v48, v20, v4
    v_fmac_f32 v49, v20, v5
    v_lshlrev_b32 v4, 16, v65
    v_and_b32 v5, 0xffff0000, v65
    v_fmac_f32 v50, v20, v4
    v_fmac_f32 v51, v20, v5
    v_lshlrev_b32 v4, 16, v66
    v_and_b32 v5, 0xffff0000, v66
    v_fmac_f32 v52, v20, v4
    v_fmac_f32 v53, v20, v5
    v_lshlrev_b32 v4, 16, v67
    v_and_b32 v5, 0xffff0000, v67
    v_fmac_f32 v54, v20, v4
    v_fmac_f32 v55, v20, v5
    v_lshlrev_b32 v4, 16, v68
    v_and_b32 v5, 0xffff0000, v68
    v_fmac_f32 v48, v21, v4
    v_fmac_f32 v49, v21, v5
    v_lshlrev_b32 v4, 16, v69
    v_and_b32 v5, 0xffff0000, v69
    v_fmac_f32 v50, v21, v4
    v_fmac_f32 v51, v21, v5
    v_lshlrev_b32 v4, 16, v70
    v_and_b32 v5, 0xffff0000, v70
    v_fmac_f32 v52, v21, v4
    v_fmac_f32 v53, v21, v5
    v_lshlrev_b32 v4, 16, v71
    v_and_b32 v5, 0xffff0000, v71
    v_fmac_f32 v54, v21, v4
    v_fmac_f32 v55, v21, v5
    v_lshlrev_b32 v4, 16, v72
    v_and_b32 v5, 0xffff0000, v72
    v_fmac_f32 v48, v22, v4
    v_fmac_f32 v49, v22, v5
    v_lshlrev_b32 v4, 16, v73
    v_and_b32 v5, 0xffff0000, v73
    v_fmac_f32 v50, v22, v4
    v_fmac_f32 v51, v22, v5
    v_lshlrev_b32 v4, 16, v74
    v_and_b32 v5, 0xffff0000, v74
    v_fmac_f32 v52, v22, v4
    v_fmac_f32 v53, v22, v5
    v_lshlrev_b32 v4, 16, v75
    v_and_b32 v5, 0xffff0000, v75
    v_fmac_f32 v54, v22, v4
    v_fmac_f32 v55, v22, v5
    v_lshlrev_b32 v4, 16, v76
    v_and_b32 v5, 0xffff0000, v76
    v_fmac_f32 v48, v23, v4
    v_fmac_f32 v49, v23, v5
    v_lshlrev_b32 v4, 16, v77
    v_and_b32 v5, 0xffff0000, v77
    v_fmac_f32 v50, v23, v4
    v_fmac_f32 v51, v23, v5
    v_lshlrev_b32 v4, 16, v78
    v_and_b32 v5, 0xffff0000, v78
    v_fmac_f32 v52, v23, v4
    v_fmac_f32 v53, v23, v5
    v_lshlrev_b32 v4, 16, v79
    v_and_b32 v5, 0xffff0000, v79
    v_fmac_f32 v54, v23, v4
    v_fmac_f32 v55, v23, v5
    v_lshlrev_b32 v4, 16, v80
    v_and_b32 v5, 0xffff0000, v80
    v_fmac_f32 v48, v24, v4
    v_fmac_f32 v49, v24, v5
    v_lshlrev_b32 v4, 16, v81
    v_and_b32 v5, 0xffff0000, v81
    v_fmac_f32 v50, v24, v4
    v_fmac_f32 v51, v24, v5
    v_lshlrev_b32 v4, 16, v82
    v_and_b32 v5, 0xffff0000, v82
    v_fmac_f32 v52, v24, v4
    v_fmac_f32 v53, v24, v5
    v_lshlrev_b32 v4, 16, v83
    v_and_b32 v5, 0xffff0000, v83
    v_fmac_f32 v54, v24, v4
    v_fmac_f32 v55, v24, v5
    v_lshlrev_b32 v4, 16, v84
    v_and_b32 v5, 0xffff0000, v84
    v_fmac_f32 v48, v25, v4
    v_fmac_f32 v49, v25, v5
    v_lshlrev_b32 v4, 16, v85
    v_and_b32 v5, 0xffff0000, v85
    v_fmac_f32 v50, v25, v4
    v_fmac_f32 v51, v25, v5
    v_lshlrev_b32 v4, 16, v86
    v_and_b32 v5, 0xffff0000, v86
    v_fmac_f32 v52, v25, v4
    v_fmac_f32 v53, v25, v5
    v_lshlrev_b32 v4, 16, v87
    v_and_b32 v5, 0xffff0000, v87
    v_fmac_f32 v54, v25, v4
    v_fmac_f32 v55, v25, v5
    v_lshlrev_b32 v4, 16, v88
    v_and_b32 v5, 0xffff0000, v88
    v_fmac_f32 v48, v26, v4
    v_fmac_f32 v49, v26, v5
    v_lshlrev_b32 v4, 16, v89
    v_and_b32 v5, 0xffff0000, v89
    v_fmac_f32 v50, v26, v4
    v_fmac_f32 v51, v26, v5
    v_lshlrev_b32 v4, 16, v90
    v_and_b32 v5, 0xffff0000, v90
    v_fmac_f32 v52, v26, v4
    v_fmac_f32 v53, v26, v5
    v_lshlrev_b32 v4, 16, v91
    v_and_b32 v5, 0xffff0000, v91
    v_fmac_f32 v54, v26, v4
    v_fmac_f32 v55, v26, v5
    v_lshlrev_b32 v4, 16, v92
    v_and_b32 v5, 0xffff0000, v92
    v_fmac_f32 v48, v27, v4
    v_fmac_f32 v49, v27, v5
    v_lshlrev_b32 v4, 16, v93
    v_and_b32 v5, 0xffff0000, v93
    v_fmac_f32 v50, v27, v4
    v_fmac_f32 v51, v27, v5
    v_lshlrev_b32 v4, 16, v94
    v_and_b32 v5, 0xffff0000, v94
    v_fmac_f32 v52, v27, v4
    v_fmac_f32 v53, v27, v5
    v_lshlrev_b32 v4, 16, v95
    v_and_b32 v5, 0xffff0000, v95
    v_fmac_f32 v54, v27, v4
    v_fmac_f32 v55, v27, v5
    v_lshlrev_b32 v4, 16, v96
    v_and_b32 v5, 0xffff0000, v96
    v_fmac_f32 v48, v28, v4
    v_fmac_f32 v49, v28, v5
    v_lshlrev_b32 v4, 16, v97
    v_and_b32 v5, 0xffff0000, v97
    v_fmac_f32 v50, v28, v4
    v_fmac_f32 v51, v28, v5
    v_lshlrev_b32 v4, 16, v98
    v_and_b32 v5, 0xffff0000, v98
    v_fmac_f32 v52, v28, v4
    v_fmac_f32 v53, v28, v5
    v_lshlrev_b32 v4, 16, v99
    v_and_b32 v5, 0xffff0000, v99
    v_fmac_f32 v54, v28, v4
    v_fmac_f32 v55, v28, v5
    v_lshlrev_b32 v4, 16, v100
    v_and_b32 v5, 0xffff0000, v100
    v_fmac_f32 v48, v29, v4
    v_fmac_f32 v49, v29, v5
    v_lshlrev_b32 v4, 16, v101
    v_and_b32 v5, 0xffff0000, v101
    v_fmac_f32 v50, v29, v4
    v_fmac_f32 v51, v29, v5
    v_lshlrev_b32 v4, 16, v102
    v_and_b32 v5, 0xffff0000, v102
    v_fmac_f32 v52, v29, v4
    v_fmac_f32 v53, v29, v5
    v_lshlrev_b32 v4, 16, v103
    v_and_b32 v5, 0xffff0000, v103
    v_fmac_f32 v54, v29, v4
    v_fmac_f32 v55, v29, v5
    v_lshlrev_b32 v4, 16, v104
    v_and_b32 v5, 0xffff0000, v104
    v_fmac_f32 v48, v30, v4
    v_fmac_f32 v49, v30, v5
    v_lshlrev_b32 v4, 16, v105
    v_and_b32 v5, 0xffff0000, v105
    v_fmac_f32 v50, v30, v4
    v_fmac_f32 v51, v30, v5
    v_lshlrev_b32 v4, 16, v106
    v_and_b32 v5, 0xffff0000, v106
    v_fmac_f32 v52, v30, v4
    v_fmac_f32 v53, v30, v5
    v_lshlrev_b32 v4, 16, v107
    v_and_b32 v5, 0xffff0000, v107
    v_fmac_f32 v54, v30, v4
    v_fmac_f32 v55, v30, v5
    v_lshlrev_b32 v4, 16, v108
    v_and_b32 v5, 0xffff0000, v108
    v_fmac_f32 v48, v31, v4
    v_fmac_f32 v49, v31, v5
    v_lshlrev_b32 v4, 16, v109
    v_and_b32 v5, 0xffff0000, v109
    v_fmac_f32 v50, v31, v4
    v_fmac_f32 v51, v31, v5
    v_lshlrev_b32 v4, 16, v110
    v_and_b32 v5, 0xffff0000, v110
    v_fmac_f32 v52, v31, v4
    v_fmac_f32 v53, v31, v5
    v_lshlrev_b32 v4, 16, v111
    v_and_b32 v5, 0xffff0000, v111
    v_fmac_f32 v54, v31, v4
    v_fmac_f32 v55, v31, v5
    v_lshlrev_b32 v4, 16, v112
    v_and_b32 v5, 0xffff0000, v112
    v_fmac_f32 v48, v32, v4
    v_fmac_f32 v49, v32, v5
    v_lshlrev_b32 v4, 16, v113
    v_and_b32 v5, 0xffff0000, v113
    v_fmac_f32 v50, v32, v4
    v_fmac_f32 v51, v32, v5
    v_lshlrev_b32 v4, 16, v114
    v_and_b32 v5, 0xffff0000, v114
    v_fmac_f32 v52, v32, v4
    v_fmac_f32 v53, v32, v5
    v_lshlrev_b32 v4, 16, v115
    v_and_b32 v5, 0xffff0000, v115
    v_fmac_f32 v54, v32, v4
    v_fmac_f32 v55, v32, v5
    v_lshlrev_b32 v4, 16, v116
    v_and_b32 v5, 0xffff0000, v116
    v_fmac_f32 v48, v33, v4
    v_fmac_f32 v49, v33, v5
    v_lshlrev_b32 v4, 16, v117
    v_and_b32 v5, 0xffff0000, v117
    v_fmac_f32 v50, v33, v4
    v_fmac_f32 v51, v33, v5
    v_lshlrev_b32 v4, 16, v118
    v_and_b32 v5, 0xffff0000, v118
    v_fmac_f32 v52, v33, v4
    v_fmac_f32 v53, v33, v5
    v_lshlrev_b32 v4, 16, v119
    v_and_b32 v5, 0xffff0000, v119
    v_fmac_f32 v54, v33, v4
    v_fmac_f32 v55, v33, v5
    v_lshlrev_b32 v4, 16, v120
    v_and_b32 v5, 0xffff0000, v120
    v_fmac_f32 v48, v34, v4
    v_fmac_f32 v49, v34, v5
    v_lshlrev_b32 v4, 16, v121
    v_and_b32 v5, 0xffff0000, v121
    v_fmac_f32 v50, v34, v4
    v_fmac_f32 v51, v34, v5
    v_lshlrev_b32 v4, 16, v122
    v_and_b32 v5, 0xffff0000, v122
    v_fmac_f32 v52, v34, v4
    v_fmac_f32 v53, v34, v5
    v_lshlrev_b32 v4, 16, v123
    v_and_b32 v5, 0xffff0000, v123
    v_fmac_f32 v54, v34, v4
    v_fmac_f32 v55, v34, v5
    v_lshlrev_b32 v4, 16, v124
    v_and_b32 v5, 0xffff0000, v124
    v_fmac_f32 v48, v35, v4
    v_fmac_f32 v49, v35, v5
    v_lshlrev_b32 v4, 16, v125
    v_and_b32 v5, 0xffff0000, v125
    v_fmac_f32 v50, v35, v4
    v_fmac_f32 v51, v35, v5
    v_lshlrev_b32 v4, 16, v126
    v_and_b32 v5, 0xffff0000, v126
    v_fmac_f32 v52, v35, v4
    v_fmac_f32 v53, v35, v5
    v_lshlrev_b32 v4, 16, v127
    v_and_b32 v5, 0xffff0000, v127
    v_fmac_f32 v54, v35, v4
    v_fmac_f32 v55, v35, v5
    s_nop 1
    v_add_f32_dpp v48, v48, v48 row_ror:8 row_mask:0xf bank_mask:0xf
    v_mov_b32 v4, v48
    s_nop 1
    v_permlane16_swap_b32 v48, v4
    s_nop 1
    v_add_f32 v48, v48, v4
    v_mov_b32 v4, v48
    s_nop 1
    v_permlane32_swap_b32 v48, v4
    s_nop 1
    v_add_f32 v48, v48, v4
    s_nop 1
    v_add_f32_dpp v49, v49, v49 row_ror:8 row_mask:0xf bank_mask:0xf
    v_mov_b32 v4, v49
    s_nop 1
    v_permlane16_swap_b32 v49, v4
    s_nop 1
    v_add_f32 v49, v49, v4
    v_mov_b32 v4, v49
    s_nop 1
    v_permlane32_swap_b32 v49, v4
    s_nop 1
    v_add_f32 v49, v49, v4
    s_nop 1
    v_add_f32_dpp v50, v50, v50 row_ror:8 row_mask:0xf bank_mask:0xf
    v_mov_b32 v4, v50
    s_nop 1
    v_permlane16_swap_b32 v50, v4
    s_nop 1
    v_add_f32 v50, v50, v4
    v_mov_b32 v4, v50
    s_nop 1
    v_permlane32_swap_b32 v50, v4
    s_nop 1
    v_add_f32 v50, v50, v4
    s_nop 1
    v_add_f32_dpp v51, v51, v51 row_ror:8 row_mask:0xf bank_mask:0xf
    v_mov_b32 v4, v51
    s_nop 1
    v_permlane16_swap_b32 v51, v4
    s_nop 1
    v_add_f32 v51, v51, v4
    v_mov_b32 v4, v51
    s_nop 1
    v_permlane32_swap_b32 v51, v4
    s_nop 1
    v_add_f32 v51, v51, v4
    s_nop 1
    v_add_f32_dpp v52, v52, v52 row_ror:8 row_mask:0xf bank_mask:0xf
    v_mov_b32 v4, v52
    s_nop 1
    v_permlane16_swap_b32 v52, v4
    s_nop 1
    v_add_f32 v52, v52, v4
    v_mov_b32 v4, v52
    s_nop 1
    v_permlane32_swap_b32 v52, v4
    s_nop 1
    v_add_f32 v52, v52, v4
    s_nop 1
    v_add_f32_dpp v53, v53, v53 row_ror:8 row_mask:0xf bank_mask:0xf
    v_mov_b32 v4, v53
    s_nop 1
    v_permlane16_swap_b32 v53, v4
    s_nop 1
    v_add_f32 v53, v53, v4
    v_mov_b32 v4, v53
    s_nop 1
    v_permlane32_swap_b32 v53, v4
    s_nop 1
    v_add_f32 v53, v53, v4
    s_nop 1
    v_add_f32_dpp v54, v54, v54 row_ror:8 row_mask:0xf bank_mask:0xf
    v_mov_b32 v4, v54
    s_nop 1
    v_permlane16_swap_b32 v54, v4
    s_nop 1
    v_add_f32 v54, v54, v4
    v_mov_b32 v4, v54
    s_nop 1
    v_permlane32_swap_b32 v54, v4
    s_nop 1
    v_add_f32 v54, v54, v4
    s_nop 1
    v_add_f32_dpp v55, v55, v55 row_ror:8 row_mask:0xf bank_mask:0xf
    v_mov_b32 v4, v55
    s_nop 1
    v_permlane16_swap_b32 v55, v4
    s_nop 1
    v_add_f32 v55, v55, v4
    v_mov_b32 v4, v55
    s_nop 1
    v_permlane32_swap_b32 v55, v4
    s_nop 1
    v_add_f32 v55, v55, v4
    s_lshl_b32 s16, s7, 13
    s_lshl_b32 s17, s6, 8
    s_add_u32 s16, s16, s17
    s_add_u32 s16, s16, 663552
    v_lshlrev_b32 v6, 5, v0
    s_mov_b64 exec, 0xff
    buffer_store_dwordx4 v[48:51], v6, s[76:79], s16 offen sc1
    buffer_store_dwordx4 v[52:55], v6, s[76:79], s16 offen offset:16 sc1
    s_mov_b64 exec, -1
    s_lshl_b32 s17, s7, 5
    s_add_u32 s17, s17, s6
    s_waitcnt vmcnt(0)
    v_mov_b32 v2, s94
    v_mov_b32 v3, s95
    s_lshl_b32 s17, s17, 3
    s_add_u32 s17, s17, 1576960
    v_mov_b32 v1, s17
    s_mov_b64 exec, 1
    buffer_store_dwordx2 v[2:3], v1, s[76:79], 0 offen sc1
    s_mov_b64 exec, -1
    s_cmp_ge_u32 s2, 8
    s_cbranch_scc1 L_end
    v_and_b32 v6, 15, v0
    v_lshlrev_b32 v8, 3, v6
    s_lshl_b32 s16, s7, 7
    buffer_load_dwordx2 v[20:21], v8, s[40:43], s16 offen
    v_and_b32 v12, 31, v0
    s_lshl_b32 s16, s7, 5
    v_add_u32 v12, s16, v12
    v_lshlrev_b32 v12, 3, v12
    v_add_u32 v12, 1576960, v12
    s_mov_b32 s16, 0
L_poll_f:
    buffer_load_dwordx2 v[10:11], v12, s[76:79], 0 offen sc1
    s_waitcnt vmcnt(0)
    v_cmp_ne_u64 vcc, s[94:95], v[10:11]
    s_nop 1
    s_cbranch_vccz L_poll_f_done
    s_add_u32 s16, s16, 1
    s_cmp_ge_u32 s16, 0x40000
    s_cbranch_scc1 L_poll_f_done
    s_sleep 2
    s_branch L_poll_f
L_poll_f_done:
    v_lshrrev_b32 v10, 4, v0
    v_lshlrev_b32 v8, 8, v10
    v_lshl_add_u32 v8, v6, 4, v8
    s_lshl_b32 s16, s7, 13
    s_add_u32 s17, s16, 663552
    buffer_load_dwordx4 v[32:35], v8, s[76:79], s17 offen sc1
    s_add_u32 s17, s16, 664576
    buffer_load_dwordx4 v[36:39], v8, s[76:79], s17 offen sc1
    s_add_u32 s17, s16, 665600
    buffer_load_dwordx4 v[40:43], v8, s[76:79], s17 offen sc1
    s_add_u32 s17, s16, 666624
    buffer_load_dwordx4 v[44:47], v8, s[76:79], s17 offen sc1
    s_add_u32 s17, s16, 667648
    buffer_load_dwordx4 v[48:51], v8, s[76:79], s17 offen sc1
    s_add_u32 s17, s16, 668672
    buffer_load_dwordx4 v[52:55], v8, s[76:79], s17 offen sc1
    s_add_u32 s17, s16, 669696
    buffer_load_dwordx4 v[56:59], v8, s[76:79], s17 offen sc1
    s_add_u32 s17, s16, 670720
    buffer_load_dwordx4 v[60:63], v8, s[76:79], s17 offen sc1
    s_add_u32 s17, s16, 729088
    buffer_load_dwordx4 v[64:67], v8, s[76:79], s17 offen sc1
    s_add_u32 s17, s16, 730112
    buffer_load_dwordx4 v[68:71], v8, s[76:79], s17 offen sc1
    s_add_u32 s17, s16, 731136
    buffer_load_dwordx4 v[72:75], v8, s[76:79], s17 offen sc1
    s_add_u32 s17, s16, 732160
    buffer_load_dwordx4 v[76:79], v8, s[76:79], s17 offen sc1
    s_add_u32 s17, s16, 733184
    buffer_load_dwordx4 v[80:83], v8, s[76:79], s17 offen sc1
    s_add_u32 s17, s16, 734208
    buffer_load_dwordx4 v[84:87], v8, s[76:79], s17 offen sc1
    s_add_u32 s17, s16, 735232
    buffer_load_dwordx4 v[88:91], v8, s[76:79], s17 offen sc1
    s_add_u32 s17, s16, 736256
    buffer_load_dwordx4 v[92:95], v8, s[76:79], s17 offen sc1
    s_waitcnt vmcnt(0)
    v_add_f32 v32, v32, v36
    v_add_f32 v33, v33, v37
    v_add_f32 v34, v34, v38
    v_add_f32 v35, v35, v39
    v_add_f32 v32, v32, v40
    v_add_f32 v33, v33, v41
    v_add_f32 v34, v34, v42
    v_add_f32 v35, v35, v43
    v_add_f32 v32, v32, v44
    v_add_f32 v33, v33, v45
    v_add_f32 v34, v34, v46
    v_add_f32 v35, v35, v47
    v_add_f32 v32, v32, v48
    v_add_f32 v33, v33, v49
    v_add_f32 v34, v34, v50
    v_add_f32 v35, v35, v51
    v_add_f32 v32, v32, v52
    v_add_f32 v33, v33, v53
    v_add_f32 v34, v34, v54
    v_add_f32 v35, v35, v55
    v_add_f32 v32, v32, v56
    v_add_f32 v33, v33, v57
    v_add_f32 v34, v34, v58
    v_add_f32 v35, v35, v59
    v_add_f32 v32, v32, v60
    v_add_f32 v33, v33, v61
    v_add_f32 v34, v34, v62
    v_add_f32 v35, v35, v63
    v_mov_b32 v4, v32
    s_nop 1
    v_permlane16_swap_b32 v32, v4
    s_nop 1
    v_add_f32 v32, v32, v4
    v_mov_b32 v4, v32
    s_nop 1
    v_permlane32_swap_b32 v32, v4
    s_nop 1
    v_add_f32 v32, v32, v4
    v_mov_b32 v4, v33
    s_nop 1
    v_permlane16_swap_b32 v33, v4
    s_nop 1
    v_add_f32 v33, v33, v4
    v_mov_b32 v4, v33
    s_nop 1
    v_permlane32_swap_b32 v33, v4
    s_nop 1
    v_add_f32 v33, v33, v4
    v_mov_b32 v4, v34
    s_nop 1
    v_permlane16_swap_b32 v34, v4
    s_nop 1
    v_add_f32 v34, v34, v4
    v_mov_b32 v4, v34
    s_nop 1
    v_permlane32_swap_b32 v34, v4
    s_nop 1
    v_add_f32 v34, v34, v4
    v_mov_b32 v4, v35
    s_nop 1
    v_permlane16_swap_b32 v35, v4
    s_nop 1
    v_add_f32 v35, v35, v4
    v_mov_b32 v4, v35
    s_nop 1
    v_permlane32_swap_b32 v35, v4
    s_nop 1
    v_add_f32 v35, v35, v4
    v_add_f32 v64, v64, v68
    v_add_f32 v65, v65, v69
    v_add_f32 v66, v66, v70
    v_add_f32 v67, v67, v71
    v_add_f32 v64, v64, v72
    v_add_f32 v65, v65, v73
    v_add_f32 v66, v66, v74
    v_add_f32 v67, v67, v75
    v_add_f32 v64, v64, v76
    v_add_f32 v65, v65, v77
    v_add_f32 v66, v66, v78
    v_add_f32 v67, v67, v79
    v_add_f32 v64, v64, v80
    v_add_f32 v65, v65, v81
    v_add_f32 v66, v66, v82
    v_add_f32 v67, v67, v83
    v_add_f32 v64, v64, v84
    v_add_f32 v65, v65, v85
    v_add_f32 v66, v66, v86
    v_add_f32 v67, v67, v87
    v_add_f32 v64, v64, v88
    v_add_f32 v65, v65, v89
    v_add_f32 v66, v66, v90
    v_add_f32 v67, v67, v91
    v_add_f32 v64, v64, v92
    v_add_f32 v65, v65, v93
    v_add_f32 v66, v66, v94
    v_add_f32 v67, v67, v95
    v_mov_b32 v4, v64
    s_nop 1
    v_permlane16_swap_b32 v64, v4
    s_nop 1
    v_add_f32 v64, v64, v4
    v_mov_b32 v4, v64
    s_nop 1
    v_permlane32_swap_b32 v64, v4
    s_nop 1
    v_add_f32 v64, v64, v4
    v_mov_b32 v4, v65
    s_nop 1
    v_permlane16_swap_b32 v65, v4
    s_nop 1
    v_add_f32 v65, v65, v4
    v_mov_b32 v4, v65
    s_nop 1
    v_permlane32_swap_b32 v65, v4
    s_nop 1
    v_add_f32 v65, v65, v4
    v_mov_b32 v4, v66
    s_nop 1
    v_permlane16_swap_b32 v66, v4
    s_nop 1
    v_add_f32 v66, v66, v4
    v_mov_b32 v4, v66
    s_nop 1
    v_permlane32_swap_b32 v66, v4
    s_nop 1
    v_add_f32 v66, v66, v4
    v_mov_b32 v4, v67
    s_nop 1
    v_permlane16_swap_b32 v67, v4
    s_nop 1
    v_add_f32 v67, v67, v4
    v_mov_b32 v4, v67
    s_nop 1
    v_permlane32_swap_b32 v67, v4
    s_nop 1
    v_add_f32 v67, v67, v4
    v_cvt_pk_bf16_f32 v4, v32, v33
    v_lshlrev_b32 v32, 16, v4
    v_and_b32 v33, 0xffff0000, v4
    v_cvt_pk_bf16_f32 v4, v34, v35
    v_lshlrev_b32 v34, 16, v4
    v_and_b32 v35, 0xffff0000, v4
    v_cvt_pk_bf16_f32 v4, v64, v65
    v_lshlrev_b32 v64, 16, v4
    v_and_b32 v65, 0xffff0000, v4
    v_cvt_pk_bf16_f32 v4, v66, v67
    v_lshlrev_b32 v66, 16, v4
    v_and_b32 v67, 0xffff0000, v4
    v_lshlrev_b32 v22, 16, v20
    v_and_b32 v23, 0xffff0000, v20
    v_lshlrev_b32 v24, 16, v21
    v_and_b32 v25, 0xffff0000, v21
    v_add_f32 v32, v22, v32
    v_add_f32 v33, v23, v33
    v_add_f32 v34, v24, v34
    v_add_f32 v35, v25, v35
    v_cvt_pk_bf16_f32 v4, v32, v33
    v_lshlrev_b32 v32, 16, v4
    v_and_b32 v33, 0xffff0000, v4
    v_cvt_pk_bf16_f32 v4, v34, v35
    v_lshlrev_b32 v34, 16, v4
    v_and_b32 v35, 0xffff0000, v4
    v_add_f32 v32, v32, v64
    v_add_f32 v33, v33, v65
    v_add_f32 v34, v34, v66
    v_add_f32 v35, v35, v67
    v_cvt_pk_bf16_f32 v36, v32, v33
    v_cvt_pk_bf16_f32 v37, v34, v35
    v_lshlrev_b32 v8, 3, v6
    s_lshl_b32 s16, s7, 7
    s_mov_b64 exec, 0xffff
    buffer_store_dwordx2 v[36:37], v8, s[68:71], s16 offen
    s_mov_b64 exec, -1
L_end:
    s_endpgm
.section .rodata,"a"
.p2align 6
.amdhsa_kernel parallel_sum__gqa_block_cached__glu_gated_swiglu__decode_kernel
  .amdhsa_next_free_vgpr 168
  .amdhsa_next_free_sgpr 102
  .amdhsa_accum_offset 168
  .amdhsa_group_segment_fixed_size 0
  .amdhsa_kernarg_size 96
  .amdhsa_user_sgpr_count 2
  .amdhsa_user_sgpr_kernarg_segment_ptr 1
  .amdhsa_system_sgpr_workgroup_id_x 1
.end_amdhsa_kernel
```
